```python
import torch

def _softmax(x, axis=-1):
    return torch.softmax(x, dim=axis)
def _gelu(x):
    return torch.nn.functional.gelu(x, approximate="tanh")
def _silu(x):
    return torch.nn.functional.silu(x)
def _sigmoid(x):
    return torch.sigmoid(x)
def _layernorm(x, axis=-1, eps=1e-5):
    m = x.mean(dim=axis, keepdim=True)
    v = x.var(dim=axis, keepdim=True, unbiased=False)
    return (x - m) / torch.sqrt(v + eps)
def _scatter_add(tgt, idx, src, axis=0):
    return tgt.clone().index_add_(axis, idx, src)
def _segment_sum(src, seg, n):
    out = torch.zeros((n,) + src.shape[1:], dtype=src.dtype)
    return out.index_add_(0, seg, src)
def _pad(x, pw):
    flat = tuple(v for pair in reversed(pw) for v in pair)
    return torch.nn.functional.pad(x, flat)

kernel_name = 'concat_heads__gqa_block_cached__mha_block_cached__near_ridge'

def setup_inputs():

    _w = (lambda a: (lambda t: t.to(torch.bfloat16) if t.is_floating_point() else t)(torch.as_tensor(a)))
    def _A_setup():
        B, Sq, D = 8, 64, 576
        Hq, Hkv, Sk, Dh = 32, 16, 1024, 128
        assert Hq % Hkv == 0, (Hq, Hkv)
        return {
            "x": _w((lambda *s: torch.randn(*s, dtype=torch.bfloat16) * 0.8)(B, Sq, D)),
            "k_cache": _w((lambda *s: torch.randn(*s, dtype=torch.bfloat16) * 0.8)(B, Hkv, Sk, Dh)),
            "v_cache": _w((lambda *s: torch.randn(*s, dtype=torch.bfloat16) * 0.05)(B, Hkv, Sk, Dh)),
            "wq": _w((lambda *s: torch.randn(*s, dtype=torch.bfloat16) * 0.8)(D, Hq * Dh) * (D ** -0.5)),
            "wo": _w((lambda *s: torch.randn(*s, dtype=torch.bfloat16) * 0.05)(Hq * Dh, D) * ((Hq * Dh) ** -0.5)),
        }
    _A_in = _A_setup()

    def _B_setup():
        B, Sq, D = 8, 64, 576
        H, Sk, Dh = 32, 1024, 128
        return {
            "x": _w((lambda *s: torch.randn(*s, dtype=torch.bfloat16) * 0.8)(B, Sq, D)),
            "k_cache": _w((lambda *s: torch.randn(*s, dtype=torch.bfloat16) * 0.8)(B, H, Sk, Dh)),
            "v_cache": _w((lambda *s: torch.randn(*s, dtype=torch.bfloat16) * 0.05)(B, H, Sk, Dh)),
            "wq": _w((lambda *s: torch.randn(*s, dtype=torch.bfloat16) * 0.8)(D, H * Dh) * (D ** -0.5)),
            "wo": _w((lambda *s: torch.randn(*s, dtype=torch.bfloat16) * 0.05)(H * Dh, D) * ((H * Dh) ** -0.5)),
        }
    _B_in = _B_setup()

    return {
        "A_x": _A_in["x"],
        "A_k_cache": _A_in["k_cache"],
        "A_v_cache": _A_in["v_cache"],
        "A_wq": _A_in["wq"],
        "A_wo": _A_in["wo"],
        "B_x": _B_in["x"],
        "B_k_cache": _B_in["k_cache"],
        "B_v_cache": _B_in["v_cache"],
        "B_wq": _B_in["wq"],
        "B_wo": _B_in["wo"],
    }

def reference(A_x, A_k_cache, A_v_cache, A_wq, A_wo, B_x, B_k_cache, B_v_cache, B_wq, B_wo):
    def _A_ref(x, k_cache, v_cache, wq, wo):
        B, Sq, D = x.shape
        Hq, Dh = 32, 128
        Hkv = k_cache.shape[1]
        rep = Hq // Hkv
        q = (lambda x, *d: x.permute(*d))((x @ wq).reshape(B, Sq, Hq, Dh), 0, 2, 1, 3)
        k = (lambda x, n, axis: torch.repeat_interleave(x, n, dim=axis))(k_cache, rep, axis=1)
        v = (lambda x, n, axis: torch.repeat_interleave(x, n, dim=axis))(v_cache, rep, axis=1)
        scores = torch.einsum("bhqd,bhkd->bhqk", q, k) * (Dh ** -0.5)
        p = _softmax(scores, axis=-1)
        o = torch.einsum("bhqk,bhkd->bhqd", p, v)
        return (lambda x, *d: x.permute(*d))(o, 0, 2, 1, 3).reshape(B, Sq, Hq * Dh) @ wo

    def _B_ref(x, k_cache, v_cache, wq, wo):
        B, Sq, D = x.shape
        H, Dh = 32, 128
        q = (lambda x, *d: x.permute(*d))((x @ wq).reshape(B, Sq, H, Dh), 0, 2, 1, 3)
        scores = torch.einsum("bhqd,bhkd->bhqk", q, k_cache) * (Dh ** -0.5)
        p = _softmax(scores, axis=-1)
        o = torch.einsum("bhqk,bhkd->bhqd", p, v_cache)
        return (lambda x, *d: x.permute(*d))(o, 0, 2, 1, 3).reshape(B, Sq, H * Dh) @ wo

    a = _A_ref(A_x, A_k_cache, A_v_cache, A_wq, A_wo)
    b = _B_ref(B_x, B_k_cache, B_v_cache, B_wq, B_wo)
    return torch.concatenate([a, b], axis=-1)
```

```asm
; @launch grid=(256,1,1) block=(256,1,1) lds=163840
.amdgcn_target "amdgcn-amd-amdhsa--gfx950"
.text
  .globl concat_heads__gqa_block_cached__mha_block_cached__near_ridge_kernel
  .p2align 8
  .type concat_heads__gqa_block_cached__mha_block_cached__near_ridge_kernel,@function
concat_heads__gqa_block_cached__mha_block_cached__near_ridge_kernel:
  s_cmp_ge_u32 s2, 256
  s_cbranch_scc1 L_k1_done
  s_load_dwordx8 s[4:11], s[0:1], 0
  s_load_dwordx8 s[12:19], s[0:1], 40
  s_load_dwordx2 s[20:21], s[0:1], 96
  s_load_dwordx2 s[22:23], s[0:1], 88
  s_load_dwordx2 s[96:97], s[0:1], 32
  s_load_dwordx2 s[98:99], s[0:1], 72
  v_lshrrev_b32 v30, 6, v0
  v_and_b32 v1, 63, v0
  v_readfirstlane_b32 s44, v30
  s_and_b32 s50, s2, 7
  s_lshr_b32 s51, s2, 3
  s_and_b32 s57, s51, 1
  s_lshr_b32 s51, s51, 1
  s_and_b32 s52, s51, 1
  s_lshr_b32 s55, s51, 1
  s_lshl_b32 s56, s50, 2
  s_lshl_b32 s53, s52, 1
  s_add_u32 s56, s56, s53
  s_lshl_b32 s53, s52, 2
  s_add_u32 s54, s55, s53
  s_and_b32 s54, s54, 7
  s_and_b32 s45, s44, 1
  s_lshr_b32 s46, s44, 1
  s_lshl_b32 s47, s44, 15
  s_waitcnt lgkmcnt(0)
  s_cmp_eq_u32 s57, 0
  s_cselect_b32 s4, s4, s12
  s_cselect_b32 s5, s5, s13
  s_cselect_b32 s6, s6, s14
  s_cselect_b32 s7, s7, s15
  s_cselect_b32 s8, s8, s16
  s_cselect_b32 s9, s9, s17
  s_cselect_b32 s10, s10, s18
  s_cselect_b32 s11, s11, s19
  s_cselect_b32 s96, s96, s98
  s_cselect_b32 s97, s97, s99
  s_add_u32 s50, s56, s45
  s_lshl_b32 s51, s55, 5
  s_add_u32 s51, s51, s50
  s_lshr_b32 s52, s56, 1
  s_lshl_b32 s53, s55, 4
  s_add_u32 s52, s52, s53
  s_cmp_eq_u32 s57, 0
  s_cselect_b32 s52, s52, s51
  s_lshl_b32 s52, s52, 18
  s_add_u32 s24, s6, s52
  s_addc_u32 s25, s7, 0
  s_and_b32 s25, s25, 0xffff
  s_mov_b32 s26, 0x40000
  s_mov_b32 s27, 0x20000
  s_add_u32 s28, s8, s52
  s_addc_u32 s29, s9, 0
  s_and_b32 s29, s29, 0xffff
  s_mov_b32 s30, 0x40000
  s_mov_b32 s31, 0x20000
  s_and_b32 s51, s2, 7
  s_lshl_b32 s51, s51, 1
  s_add_u32 s51, s51, s57
  s_lshl_b32 s51, s51, 3
  s_add_u32 s51, s51, s55
  s_lshl_b32 s51, s51, 2
  s_and_b32 s52, s50, 3
  s_add_u32 s51, s51, s52
  s_lshl_b32 s51, s51, 14
  s_add_u32 s40, s20, s51
  s_addc_u32 s41, s21, 0
  s_and_b32 s41, s41, 0xffff
  s_mov_b32 s42, 16384
  s_mov_b32 s43, 0x20000
  s_mul_i32 s51, s55, 73728
  s_add_u32 s32, s4, s51
  s_addc_u32 s33, s5, 0
  s_and_b32 s33, s33, 0xffff
  s_mov_b32 s34, 73728
  s_mov_b32 s35, 0x20000
  s_lshl_b32 s51, s50, 8
  s_lshl_b32 s52, s46, 7
  s_add_u32 s51, s51, s52
  s_add_u32 s36, s10, s51
  s_addc_u32 s37, s11, 0
  s_and_b32 s37, s37, 0xffff
  s_sub_u32 s38, 4718592, s51
  s_mov_b32 s39, 0x20000
  v_lshrrev_b32 v30, 4, v1
  s_lshl_b32 s51, s45, 2
  v_or_b32 v30, s51, v30
  v_and_b32 v31, 7, v1
  v_xor_b32 v30, v30, v31
  v_lshlrev_b32 v30, 4, v30
  v_lshrrev_b32 v31, 3, v1
  v_mul_u32_u24 v32, 1152, v31
  v_add_u32 v204, v30, v32
  v_lshrrev_b32 v30, 4, v1
  v_and_b32 v30, 1, v30
  v_lshlrev_b32 v30, 2, v30
  v_and_b32 v32, 7, v1
  v_xor_b32 v30, v30, v32
  v_lshlrev_b32 v30, 4, v30
  v_lshlrev_b32 v31, 13, v31
  v_add_u32 v200, v30, v31
  v_add_u32 v201, 64512, v200
  v_add_u32 v202, 129024, v200
  v_add_u32 v203, 193536, v200
  s_or_b32 s50, s2, s44
  s_cmp_eq_u32 s50, 0
  s_cbranch_scc0 L_k1_nonce_done
  s_memrealtime s[62:63]
  s_waitcnt lgkmcnt(0)
  s_or_b32 s62, s62, 1
  v_mov_b32 v30, s62
  v_mov_b32 v31, 0
  s_mov_b64 s[62:63], exec
  s_mov_b64 exec, 1
  global_store_dword v31, v30, s[22:23] sc1
  s_mov_b64 exec, s[62:63]
L_k1_nonce_done:
  s_mov_b32 s61, 0x3e0293ee
  s_mul_i32 s59, s44, 9216
  s_lshl_b32 s60, s44, 10
  s_add_u32 s4, s54, 0
  s_cmp_ge_u32 s4, 9
  s_cselect_b32 s53, 9, 0
  s_sub_u32 s4, s4, s53
  s_lshl_b32 s4, s4, 19
  s_lshr_b32 s13, s4, 12
  s_add_u32 s13, s13, s59
  s_add_u32 m0, s60, 131072
  s_add_u32 s14, s13, 36864
  buffer_load_dwordx4 v204, s[32:35], s13 offen  lds
  s_add_u32 m0, s60, 135168
  s_nop 0
  buffer_load_dwordx4 v204, s[32:35], s14 offen  lds
  s_add_u32 m0, s47, 16384
  s_nop 0
  buffer_load_dwordx4 v200, s[36:39], s4 offen offset:0  lds
  buffer_load_dwordx4 v201, s[36:39], s4 offen offset:1024  lds
  buffer_load_dwordx4 v202, s[36:39], s4 offen offset:2048  lds
  buffer_load_dwordx4 v203, s[36:39], s4 offen offset:3072  lds
  s_add_u32 m0, s47, 20480
  s_add_u32 s13, s4, 262144
  buffer_load_dwordx4 v200, s[36:39], s13 offen offset:0  lds
  buffer_load_dwordx4 v201, s[36:39], s13 offen offset:1024  lds
  buffer_load_dwordx4 v202, s[36:39], s13 offen offset:2048  lds
  buffer_load_dwordx4 v203, s[36:39], s13 offen offset:3072  lds
  s_add_u32 s5, s54, 1
  s_cmp_ge_u32 s5, 9
  s_cselect_b32 s53, 9, 0
  s_sub_u32 s5, s5, s53
  s_lshl_b32 s5, s5, 19
  s_add_u32 s6, s54, 2
  s_cmp_ge_u32 s6, 9
  s_cselect_b32 s53, 9, 0
  s_sub_u32 s6, s6, s53
  s_lshl_b32 s6, s6, 19
  s_add_u32 s7, s54, 3
  s_cmp_ge_u32 s7, 9
  s_cselect_b32 s53, 9, 0
  s_sub_u32 s7, s7, s53
  s_lshl_b32 s7, s7, 19
  s_add_u32 s8, s54, 4
  s_cmp_ge_u32 s8, 9
  s_cselect_b32 s53, 9, 0
  s_sub_u32 s8, s8, s53
  s_lshl_b32 s8, s8, 19
  s_add_u32 s9, s54, 5
  s_cmp_ge_u32 s9, 9
  s_cselect_b32 s53, 9, 0
  s_sub_u32 s9, s9, s53
  s_lshl_b32 s9, s9, 19
  s_add_u32 s10, s54, 6
  s_cmp_ge_u32 s10, 9
  s_cselect_b32 s53, 9, 0
  s_sub_u32 s10, s10, s53
  s_lshl_b32 s10, s10, 19
  s_add_u32 s11, s54, 7
  s_cmp_ge_u32 s11, 9
  s_cselect_b32 s53, 9, 0
  s_sub_u32 s11, s11, s53
  s_lshl_b32 s11, s11, 19
  s_add_u32 s12, s54, 8
  s_cmp_ge_u32 s12, 9
  s_cselect_b32 s53, 9, 0
  s_sub_u32 s12, s12, s53
  s_lshl_b32 s12, s12, 19
  v_lshrrev_b32 v30, 4, v1
  v_lshlrev_b32 v31, 2, v30
  v_and_b32 v32, 15, v1
  v_xor_b32 v31, v31, v32
  v_lshlrev_b32 v30, 8, v30
  v_xor_b32 v32, 0, v31
  v_lshlrev_b32 v32, 4, v32
  v_add_u32 v2, v30, v32
  v_xor_b32 v32, 1, v31
  v_lshlrev_b32 v32, 4, v32
  v_add_u32 v3, v30, v32
  v_add_u32 v3, 1024, v3
  v_xor_b32 v32, 2, v31
  v_lshlrev_b32 v32, 4, v32
  v_add_u32 v4, v30, v32
  v_add_u32 v4, 2048, v4
  v_xor_b32 v32, 3, v31
  v_lshlrev_b32 v32, 4, v32
  v_add_u32 v5, v30, v32
  v_add_u32 v5, 3072, v5
  s_lshl_b32 s48, s46, 10
  v_and_b32 v30, 31, v1
  v_and_b32 v31, 3, v30
  v_lshlrev_b32 v31, 2, v31
  v_bfe_u32 v32, v30, 2, 2
  v_or_b32 v31, v31, v32
  v_lshrrev_b32 v32, 5, v1
  v_xor_b32 v31, v31, v32
  v_lshlrev_b32 v31, 4, v31
  v_lshlrev_b32 v30, 8, v30
  v_add_u32 v30, v30, v31
  v_add_u32 v6, s47, v30
  v_xor_b32 v7, 32, v6
  v_xor_b32 v8, 64, v6
  v_xor_b32 v9, 96, v6
  v_xor_b32 v10, 128, v6
  v_xor_b32 v11, 160, v6
  v_xor_b32 v12, 192, v6
  v_xor_b32 v13, 224, v6
  v_bfe_u32 v30, v1, 4, 1
  v_lshlrev_b32 v30, 1, v30
  v_bfe_u32 v31, v1, 1, 1
  v_or_b32 v30, v30, v31
  v_bfe_u32 v31, v1, 2, 2
  v_lshlrev_b32 v32, 2, v31
  v_xor_b32 v30, v30, v32
  v_lshrrev_b32 v32, 5, v1
  v_xor_b32 v30, v30, v32
  v_lshlrev_b32 v30, 4, v30
  v_lshlrev_b32 v32, 2, v32
  v_add_u32 v31, v31, v32
  v_lshlrev_b32 v31, 8, v31
  v_add_u32 v30, v30, v31
  v_and_b32 v31, 1, v1
  v_lshlrev_b32 v31, 3, v31
  v_add_u32 v30, v30, v31
  v_add_u32 v30, s47, v30
  v_xor_b32 v14, 0, v30
  v_xor_b32 v15, 32, v30
  v_add_u32 v15, 2048, v15
  v_xor_b32 v16, 64, v30
  v_xor_b32 v17, 96, v30
  v_add_u32 v17, 2048, v17
  v_xor_b32 v18, 128, v30
  v_xor_b32 v19, 160, v30
  v_add_u32 v19, 2048, v19
  v_xor_b32 v20, 192, v30
  v_xor_b32 v21, 224, v30
  v_add_u32 v21, 2048, v21
  v_bfe_u32 v30, v1, 4, 1
  v_lshlrev_b32 v30, 1, v30
  v_and_b32 v31, 1, v1
  v_or_b32 v30, v30, v31
  v_bfe_u32 v31, v1, 3, 1
  v_lshlrev_b32 v31, 2, v31
  v_xor_b32 v30, v30, v31
  v_lshlrev_b32 v30, 4, v30
  v_bfe_u32 v31, v1, 2, 2
  v_lshrrev_b32 v32, 5, v1
  v_lshlrev_b32 v32, 3, v32
  v_add_u32 v31, v31, v32
  v_lshlrev_b32 v31, 7, v31
  v_add_u32 v30, v30, v31
  v_bfe_u32 v31, v1, 1, 1
  v_lshlrev_b32 v31, 3, v31
  v_add_u32 v30, v30, v31
  v_add_u32 v30, s47, v30
  v_mov_b32 v205, v30
  v_xor_b32 v206, 64, v205
  v_and_b32 v30, 31, v1
  v_bfe_u32 v31, v30, 1, 3
  v_lshrrev_b32 v32, 5, v1
  v_xor_b32 v31, v31, v32
  v_lshlrev_b32 v31, 4, v31
  v_lshlrev_b32 v30, 7, v30
  v_add_u32 v30, v30, v31
  v_mov_b32 v207, v30
  v_xor_b32 v208, 32, v207
  v_xor_b32 v209, 64, v207
  v_xor_b32 v210, 96, v207
  s_and_b32 s88, s2, 7
  s_lshr_b32 s89, s55, 1
  s_and_b32 s50, s55, 1
  s_lshl_b32 s50, s50, 1
  s_bfe_u32 s51, s56, 0x10001
  s_add_u32 s90, s50, s51
  s_mul_i32 s50, s88, 589824
  s_mul_i32 s51, s90, 288
  s_add_u32 s50, s50, s51
  s_add_u32 s96, s96, s50
  s_addc_u32 s97, s97, 0
  s_and_b32 s97, s97, 0xffff
  s_sub_u32 s98, 4718592, s50
  s_mov_b32 s99, 0x20000
  s_add_u32 s91, s89, s90
  s_and_b32 s91, s91, 3
  s_lshl_b32 s91, s91, 2
  s_add_u32 s52, s91, 0
  s_add_u32 s52, s52, s44
  s_and_b32 s52, s52, 15
  s_mul_i32 s92, s52, 36864
  s_add_u32 s52, s91, 4
  s_add_u32 s52, s52, s44
  s_and_b32 s52, s52, 15
  s_mul_i32 s93, s52, 36864
  s_add_u32 s52, s91, 8
  s_add_u32 s52, s52, s44
  s_and_b32 s52, s52, 15
  s_mul_i32 s94, s52, 36864
  s_add_u32 s52, s91, 12
  s_add_u32 s52, s52, s44
  s_and_b32 s52, s52, 15
  s_mul_i32 s95, s52, 36864
  v_add_u32 v30, 0, v1
  v_mul_u32_u24 v31, 3641, v30
  v_lshrrev_b32 v31, 16, v31
  v_mul_u32_u24 v32, 18, v31
  v_sub_u32 v32, v30, v32
  v_mul_u32_u24 v31, 1152, v31
  v_lshlrev_b32 v32, 4, v32
  v_add_u32 v224, v31, v32
  v_add_u32 v30, 64, v1
  v_mul_u32_u24 v31, 3641, v30
  v_lshrrev_b32 v31, 16, v31
  v_mul_u32_u24 v32, 18, v31
  v_sub_u32 v32, v30, v32
  v_mul_u32_u24 v31, 1152, v31
  v_lshlrev_b32 v32, 4, v32
  v_add_u32 v225, v31, v32
  v_add_u32 v30, 128, v1
  v_mul_u32_u24 v31, 3641, v30
  v_lshrrev_b32 v31, 16, v31
  v_mul_u32_u24 v32, 18, v31
  v_sub_u32 v32, v30, v32
  v_mul_u32_u24 v31, 1152, v31
  v_lshlrev_b32 v32, 4, v32
  v_add_u32 v226, v31, v32
  v_add_u32 v30, 192, v1
  v_mul_u32_u24 v31, 3641, v30
  v_lshrrev_b32 v31, 16, v31
  v_mul_u32_u24 v32, 18, v31
  v_sub_u32 v32, v30, v32
  v_mul_u32_u24 v31, 1152, v31
  v_lshlrev_b32 v32, 4, v32
  v_add_u32 v227, v31, v32
  v_add_u32 v30, 256, v1
  v_mul_u32_u24 v31, 3641, v30
  v_lshrrev_b32 v31, 16, v31
  v_mul_u32_u24 v32, 18, v31
  v_sub_u32 v32, v30, v32
  v_mul_u32_u24 v31, 1152, v31
  v_lshlrev_b32 v32, 4, v32
  v_add_u32 v228, v31, v32
  v_add_u32 v30, 320, v1
  v_mul_u32_u24 v31, 3641, v30
  v_lshrrev_b32 v31, 16, v31
  v_mul_u32_u24 v32, 18, v31
  v_sub_u32 v32, v30, v32
  v_mul_u32_u24 v31, 1152, v31
  v_lshlrev_b32 v32, 4, v32
  v_add_u32 v229, v31, v32
  v_add_u32 v30, 384, v1
  v_mul_u32_u24 v31, 3641, v30
  v_lshrrev_b32 v31, 16, v31
  v_mul_u32_u24 v32, 18, v31
  v_sub_u32 v32, v30, v32
  v_mul_u32_u24 v31, 1152, v31
  v_lshlrev_b32 v32, 4, v32
  v_add_u32 v230, v31, v32
  v_add_u32 v30, 448, v1
  v_mul_u32_u24 v31, 3641, v30
  v_lshrrev_b32 v31, 16, v31
  v_mul_u32_u24 v32, 18, v31
  v_sub_u32 v32, v30, v32
  v_mul_u32_u24 v31, 1152, v31
  v_lshlrev_b32 v32, 4, v32
  v_add_u32 v231, v31, v32
  v_add_u32 v30, 512, v1
  v_mul_u32_u24 v31, 3641, v30
  v_lshrrev_b32 v31, 16, v31
  v_mul_u32_u24 v32, 18, v31
  v_sub_u32 v32, v30, v32
  v_mul_u32_u24 v31, 1152, v31
  v_lshlrev_b32 v32, 4, v32
  v_add_u32 v232, v31, v32
  v_accvgpr_write_b32 a0, 0
  v_accvgpr_write_b32 a1, 0
  v_accvgpr_write_b32 a2, 0
  v_accvgpr_write_b32 a3, 0
  v_accvgpr_write_b32 a4, 0
  v_accvgpr_write_b32 a5, 0
  v_accvgpr_write_b32 a6, 0
  v_accvgpr_write_b32 a7, 0
  v_accvgpr_write_b32 a8, 0
  v_accvgpr_write_b32 a9, 0
  v_accvgpr_write_b32 a10, 0
  v_accvgpr_write_b32 a11, 0
  v_accvgpr_write_b32 a12, 0
  v_accvgpr_write_b32 a13, 0
  v_accvgpr_write_b32 a14, 0
  v_accvgpr_write_b32 a15, 0
  v_accvgpr_write_b32 a16, 0
  v_accvgpr_write_b32 a17, 0
  v_accvgpr_write_b32 a18, 0
  v_accvgpr_write_b32 a19, 0
  v_accvgpr_write_b32 a20, 0
  v_accvgpr_write_b32 a21, 0
  v_accvgpr_write_b32 a22, 0
  v_accvgpr_write_b32 a23, 0
  v_accvgpr_write_b32 a24, 0
  v_accvgpr_write_b32 a25, 0
  v_accvgpr_write_b32 a26, 0
  v_accvgpr_write_b32 a27, 0
  v_accvgpr_write_b32 a28, 0
  v_accvgpr_write_b32 a29, 0
  v_accvgpr_write_b32 a30, 0
  v_accvgpr_write_b32 a31, 0
  v_accvgpr_write_b32 a32, 0
  v_accvgpr_write_b32 a33, 0
  v_accvgpr_write_b32 a34, 0
  v_accvgpr_write_b32 a35, 0
  v_accvgpr_write_b32 a36, 0
  v_accvgpr_write_b32 a37, 0
  v_accvgpr_write_b32 a38, 0
  v_accvgpr_write_b32 a39, 0
  v_accvgpr_write_b32 a40, 0
  v_accvgpr_write_b32 a41, 0
  v_accvgpr_write_b32 a42, 0
  v_accvgpr_write_b32 a43, 0
  v_accvgpr_write_b32 a44, 0
  v_accvgpr_write_b32 a45, 0
  v_accvgpr_write_b32 a46, 0
  v_accvgpr_write_b32 a47, 0
  v_accvgpr_write_b32 a48, 0
  v_accvgpr_write_b32 a49, 0
  v_accvgpr_write_b32 a50, 0
  v_accvgpr_write_b32 a51, 0
  v_accvgpr_write_b32 a52, 0
  v_accvgpr_write_b32 a53, 0
  v_accvgpr_write_b32 a54, 0
  v_accvgpr_write_b32 a55, 0
  v_accvgpr_write_b32 a56, 0
  v_accvgpr_write_b32 a57, 0
  v_accvgpr_write_b32 a58, 0
  v_accvgpr_write_b32 a59, 0
  v_accvgpr_write_b32 a60, 0
  v_accvgpr_write_b32 a61, 0
  v_accvgpr_write_b32 a62, 0
  v_accvgpr_write_b32 a63, 0
  v_accvgpr_write_b32 a64, 0
  v_accvgpr_write_b32 a65, 0
  v_accvgpr_write_b32 a66, 0
  v_accvgpr_write_b32 a67, 0
  v_accvgpr_write_b32 a68, 0
  v_accvgpr_write_b32 a69, 0
  v_accvgpr_write_b32 a70, 0
  v_accvgpr_write_b32 a71, 0
  v_accvgpr_write_b32 a72, 0
  v_accvgpr_write_b32 a73, 0
  v_accvgpr_write_b32 a74, 0
  v_accvgpr_write_b32 a75, 0
  v_accvgpr_write_b32 a76, 0
  v_accvgpr_write_b32 a77, 0
  v_accvgpr_write_b32 a78, 0
  v_accvgpr_write_b32 a79, 0
  v_accvgpr_write_b32 a80, 0
  v_accvgpr_write_b32 a81, 0
  v_accvgpr_write_b32 a82, 0
  v_accvgpr_write_b32 a83, 0
  v_accvgpr_write_b32 a84, 0
  v_accvgpr_write_b32 a85, 0
  v_accvgpr_write_b32 a86, 0
  v_accvgpr_write_b32 a87, 0
  v_accvgpr_write_b32 a88, 0
  v_accvgpr_write_b32 a89, 0
  v_accvgpr_write_b32 a90, 0
  v_accvgpr_write_b32 a91, 0
  v_accvgpr_write_b32 a92, 0
  v_accvgpr_write_b32 a93, 0
  v_accvgpr_write_b32 a94, 0
  v_accvgpr_write_b32 a95, 0
  v_accvgpr_write_b32 a96, 0
  v_accvgpr_write_b32 a97, 0
  v_accvgpr_write_b32 a98, 0
  v_accvgpr_write_b32 a99, 0
  v_accvgpr_write_b32 a100, 0
  v_accvgpr_write_b32 a101, 0
  v_accvgpr_write_b32 a102, 0
  v_accvgpr_write_b32 a103, 0
  v_accvgpr_write_b32 a104, 0
  v_accvgpr_write_b32 a105, 0
  v_accvgpr_write_b32 a106, 0
  v_accvgpr_write_b32 a107, 0
  v_accvgpr_write_b32 a108, 0
  v_accvgpr_write_b32 a109, 0
  v_accvgpr_write_b32 a110, 0
  v_accvgpr_write_b32 a111, 0
  v_accvgpr_write_b32 a112, 0
  v_accvgpr_write_b32 a113, 0
  v_accvgpr_write_b32 a114, 0
  v_accvgpr_write_b32 a115, 0
  v_accvgpr_write_b32 a116, 0
  v_accvgpr_write_b32 a117, 0
  v_accvgpr_write_b32 a118, 0
  v_accvgpr_write_b32 a119, 0
  v_accvgpr_write_b32 a120, 0
  v_accvgpr_write_b32 a121, 0
  v_accvgpr_write_b32 a122, 0
  v_accvgpr_write_b32 a123, 0
  v_accvgpr_write_b32 a124, 0
  v_accvgpr_write_b32 a125, 0
  v_accvgpr_write_b32 a126, 0
  v_accvgpr_write_b32 a127, 0
  v_mov_b32 v26, 0
  v_mov_b32 v27, 0
  v_mov_b32 v28, 0
  v_mov_b32 v29, 0
  s_lshr_b32 s13, s5, 12
  s_add_u32 s13, s13, s59
  s_add_u32 m0, s60, 139264
  s_add_u32 s14, s13, 36864
  buffer_load_dwordx4 v204, s[32:35], s13 offen  lds
  s_add_u32 m0, s60, 143360
  s_nop 0
  buffer_load_dwordx4 v204, s[32:35], s14 offen  lds
  s_add_u32 m0, s47, 24576
  s_nop 0
  buffer_load_dwordx4 v200, s[36:39], s5 offen offset:0  lds
  buffer_load_dwordx4 v201, s[36:39], s5 offen offset:1024  lds
  buffer_load_dwordx4 v202, s[36:39], s5 offen offset:2048  lds
  buffer_load_dwordx4 v203, s[36:39], s5 offen offset:3072  lds
  s_add_u32 m0, s47, 28672
  s_add_u32 s13, s5, 262144
  buffer_load_dwordx4 v200, s[36:39], s13 offen offset:0  lds
  buffer_load_dwordx4 v201, s[36:39], s13 offen offset:1024  lds
  buffer_load_dwordx4 v202, s[36:39], s13 offen offset:2048  lds
  buffer_load_dwordx4 v203, s[36:39], s13 offen offset:3072  lds
  s_waitcnt vmcnt(14)
  s_barrier
  v_add_u32 v211, 131072, v207
  v_add_u32 v212, 131072, v208
  v_add_u32 v213, 131072, v209
  v_add_u32 v214, 131072, v210
  ds_read_b64_tr_b16 v[40:41], v205 offset:16384
  ds_read_b64_tr_b16 v[42:43], v205 offset:16896
  ds_read_b64_tr_b16 v[44:45], v206 offset:16384
  ds_read_b64_tr_b16 v[46:47], v206 offset:16896
  ds_read_b128 v[48:51], v211 offset:0
  ds_read_b128 v[52:55], v211 offset:4096
  ds_read_b64_tr_b16 v[56:57], v205 offset:18432
  ds_read_b64_tr_b16 v[58:59], v205 offset:18944
  ds_read_b64_tr_b16 v[60:61], v206 offset:18432
  ds_read_b64_tr_b16 v[62:63], v206 offset:18944
  ds_read_b128 v[64:67], v212 offset:0
  ds_read_b128 v[68:71], v212 offset:4096
  s_waitcnt vmcnt(10)
  s_waitcnt lgkmcnt(6)
  v_mfma_f32_32x32x16_bf16 v[104:119], v[40:43], v[48:51], 0
  ds_read_b64_tr_b16 v[72:73], v205 offset:20480
  ds_read_b64_tr_b16 v[74:75], v205 offset:20992
  ds_read_b64_tr_b16 v[76:77], v206 offset:20480
  v_mfma_f32_32x32x16_bf16 v[120:135], v[40:43], v[52:55], 0
  s_add_u32 m0, s47, 0
  s_nop 0
  buffer_load_dwordx4 v200, s[36:39], s6 offen offset:0  lds
  ds_read_b64_tr_b16 v[78:79], v206 offset:20992
  v_mfma_f32_32x32x16_bf16 v[136:151], v[44:47], v[48:51], 0
  buffer_load_dwordx4 v201, s[36:39], s6 offen offset:1024  lds
  ds_read_b128 v[80:83], v213 offset:0
  v_mfma_f32_32x32x16_bf16 v[152:167], v[44:47], v[52:55], 0
  buffer_load_dwordx4 v202, s[36:39], s6 offen offset:2048  lds
  ds_read_b128 v[84:87], v213 offset:4096
  s_waitcnt lgkmcnt(6)
  v_mfma_f32_32x32x16_bf16 v[104:119], v[56:59], v[64:67], v[104:119]
  ds_read_b64_tr_b16 v[40:41], v205 offset:22528
  ds_read_b64_tr_b16 v[42:43], v205 offset:23040
  ds_read_b64_tr_b16 v[44:45], v206 offset:22528
  v_mfma_f32_32x32x16_bf16 v[120:135], v[56:59], v[68:71], v[120:135]
  buffer_load_dwordx4 v203, s[36:39], s6 offen offset:3072  lds
  ds_read_b64_tr_b16 v[46:47], v206 offset:23040
  v_mfma_f32_32x32x16_bf16 v[136:151], v[60:63], v[64:67], v[136:151]
  s_lshr_b32 s13, s6, 12
  s_add_u32 s13, s13, s59
  s_add_u32 m0, s60, 147456
  s_add_u32 s14, s13, 36864
  buffer_load_dwordx4 v204, s[32:35], s13 offen  lds
  ds_read_b128 v[48:51], v214 offset:0
  v_mfma_f32_32x32x16_bf16 v[152:167], v[60:63], v[68:71], v[152:167]
  s_add_u32 m0, s60, 151552
  s_nop 0
  buffer_load_dwordx4 v204, s[32:35], s14 offen  lds
  ds_read_b128 v[52:55], v214 offset:4096
  s_waitcnt vmcnt(10)
  s_barrier
  v_add_u32 v211, 139264, v207
  v_add_u32 v212, 139264, v208
  v_add_u32 v213, 139264, v209
  v_add_u32 v214, 139264, v210
  s_waitcnt lgkmcnt(6)
  v_mfma_f32_32x32x16_bf16 v[104:119], v[72:75], v[80:83], v[104:119]
  ds_read_b64_tr_b16 v[56:57], v205 offset:24576
  ds_read_b64_tr_b16 v[58:59], v205 offset:25088
  ds_read_b64_tr_b16 v[60:61], v206 offset:24576
  v_mfma_f32_32x32x16_bf16 v[120:135], v[72:75], v[84:87], v[120:135]
  s_add_u32 m0, s47, 4096
  s_add_u32 s13, s6, 262144
  buffer_load_dwordx4 v200, s[36:39], s13 offen offset:0  lds
  ds_read_b64_tr_b16 v[62:63], v206 offset:25088
  v_mfma_f32_32x32x16_bf16 v[136:151], v[76:79], v[80:83], v[136:151]
  buffer_load_dwordx4 v201, s[36:39], s13 offen offset:1024  lds
  ds_read_b128 v[64:67], v211 offset:0
  v_mfma_f32_32x32x16_bf16 v[152:167], v[76:79], v[84:87], v[152:167]
  buffer_load_dwordx4 v202, s[36:39], s13 offen offset:2048  lds
  ds_read_b128 v[68:71], v211 offset:4096
  s_waitcnt lgkmcnt(6)
  v_mfma_f32_32x32x16_bf16 v[104:119], v[40:43], v[48:51], v[104:119]
  ds_read_b64_tr_b16 v[72:73], v205 offset:26624
  ds_read_b64_tr_b16 v[74:75], v205 offset:27136
  ds_read_b64_tr_b16 v[76:77], v206 offset:26624
  v_mfma_f32_32x32x16_bf16 v[120:135], v[40:43], v[52:55], v[120:135]
  buffer_load_dwordx4 v203, s[36:39], s13 offen offset:3072  lds
  ds_read_b64_tr_b16 v[78:79], v206 offset:27136
  v_mfma_f32_32x32x16_bf16 v[136:151], v[44:47], v[48:51], v[136:151]
  s_add_u32 m0, s47, 8192
  s_nop 0
  buffer_load_dwordx4 v200, s[36:39], s7 offen offset:0  lds
  ds_read_b128 v[80:83], v212 offset:0
  v_mfma_f32_32x32x16_bf16 v[152:167], v[44:47], v[52:55], v[152:167]
  buffer_load_dwordx4 v201, s[36:39], s7 offen offset:1024  lds
  ds_read_b128 v[84:87], v212 offset:4096
  s_waitcnt vmcnt(12)
  s_waitcnt lgkmcnt(6)
  v_mfma_f32_32x32x16_bf16 v[104:119], v[56:59], v[64:67], v[104:119]
  ds_read_b64_tr_b16 v[40:41], v205 offset:28672
  ds_read_b64_tr_b16 v[42:43], v205 offset:29184
  ds_read_b64_tr_b16 v[44:45], v206 offset:28672
  v_mfma_f32_32x32x16_bf16 v[120:135], v[56:59], v[68:71], v[120:135]
  buffer_load_dwordx4 v202, s[36:39], s7 offen offset:2048  lds
  ds_read_b64_tr_b16 v[46:47], v206 offset:29184
  v_mfma_f32_32x32x16_bf16 v[136:151], v[60:63], v[64:67], v[136:151]
  buffer_load_dwordx4 v203, s[36:39], s7 offen offset:3072  lds
  ds_read_b128 v[48:51], v213 offset:0
  v_mfma_f32_32x32x16_bf16 v[152:167], v[60:63], v[68:71], v[152:167]
  s_lshr_b32 s13, s7, 12
  s_add_u32 s13, s13, s59
  s_add_u32 m0, s60, 155648
  s_add_u32 s14, s13, 36864
  buffer_load_dwordx4 v204, s[32:35], s13 offen  lds
  ds_read_b128 v[52:55], v213 offset:4096
  s_waitcnt lgkmcnt(6)
  v_mfma_f32_32x32x16_bf16 v[104:119], v[72:75], v[80:83], v[104:119]
  ds_read_b64_tr_b16 v[56:57], v205 offset:30720
  ds_read_b64_tr_b16 v[58:59], v205 offset:31232
  ds_read_b64_tr_b16 v[60:61], v206 offset:30720
  v_mfma_f32_32x32x16_bf16 v[120:135], v[72:75], v[84:87], v[120:135]
  s_add_u32 m0, s60, 159744
  s_nop 0
  buffer_load_dwordx4 v204, s[32:35], s14 offen  lds
  ds_read_b64_tr_b16 v[62:63], v206 offset:31232
  v_mfma_f32_32x32x16_bf16 v[136:151], v[76:79], v[80:83], v[136:151]
  s_add_u32 m0, s47, 12288
  s_add_u32 s13, s7, 262144
  buffer_load_dwordx4 v200, s[36:39], s13 offen offset:0  lds
  ds_read_b128 v[64:67], v214 offset:0
  v_mfma_f32_32x32x16_bf16 v[152:167], v[76:79], v[84:87], v[152:167]
  buffer_load_dwordx4 v201, s[36:39], s13 offen offset:1024  lds
  ds_read_b128 v[68:71], v214 offset:4096
  s_waitcnt vmcnt(12)
  s_barrier
  v_add_u32 v211, 147456, v207
  v_add_u32 v212, 147456, v208
  v_add_u32 v213, 147456, v209
  v_add_u32 v214, 147456, v210
  s_waitcnt lgkmcnt(6)
  v_mfma_f32_32x32x16_bf16 v[104:119], v[40:43], v[48:51], v[104:119]
  ds_read_b64_tr_b16 v[72:73], v205 offset:0
  ds_read_b64_tr_b16 v[74:75], v205 offset:512
  ds_read_b64_tr_b16 v[76:77], v206 offset:0
  v_mfma_f32_32x32x16_bf16 v[120:135], v[40:43], v[52:55], v[120:135]
  buffer_load_dwordx4 v202, s[36:39], s13 offen offset:2048  lds
  ds_read_b64_tr_b16 v[78:79], v206 offset:512
  v_mfma_f32_32x32x16_bf16 v[136:151], v[44:47], v[48:51], v[136:151]
  buffer_load_dwordx4 v203, s[36:39], s13 offen offset:3072  lds
  ds_read_b128 v[80:83], v211 offset:0
  v_mfma_f32_32x32x16_bf16 v[152:167], v[44:47], v[52:55], v[152:167]
  s_add_u32 m0, s47, 16384
  s_nop 0
  buffer_load_dwordx4 v200, s[36:39], s8 offen offset:0  lds
  ds_read_b128 v[84:87], v211 offset:4096
  s_waitcnt lgkmcnt(6)
  v_mfma_f32_32x32x16_bf16 v[104:119], v[56:59], v[64:67], v[104:119]
  ds_read_b64_tr_b16 v[40:41], v205 offset:2048
  ds_read_b64_tr_b16 v[42:43], v205 offset:2560
  ds_read_b64_tr_b16 v[44:45], v206 offset:2048
  v_mfma_f32_32x32x16_bf16 v[120:135], v[56:59], v[68:71], v[120:135]
  buffer_load_dwordx4 v201, s[36:39], s8 offen offset:1024  lds
  ds_read_b64_tr_b16 v[46:47], v206 offset:2560
  v_mfma_f32_32x32x16_bf16 v[136:151], v[60:63], v[64:67], v[136:151]
  buffer_load_dwordx4 v202, s[36:39], s8 offen offset:2048  lds
  ds_read_b128 v[48:51], v212 offset:0
  v_mfma_f32_32x32x16_bf16 v[152:167], v[60:63], v[68:71], v[152:167]
  buffer_load_dwordx4 v203, s[36:39], s8 offen offset:3072  lds
  ds_read_b128 v[52:55], v212 offset:4096
  s_waitcnt vmcnt(14)
  s_waitcnt lgkmcnt(6)
  v_mfma_f32_32x32x16_bf16 v[104:119], v[72:75], v[80:83], v[104:119]
  ds_read_b64_tr_b16 v[56:57], v205 offset:4096
  ds_read_b64_tr_b16 v[58:59], v205 offset:4608
  ds_read_b64_tr_b16 v[60:61], v206 offset:4096
  v_mfma_f32_32x32x16_bf16 v[120:135], v[72:75], v[84:87], v[120:135]
  s_add_u32 m0, s47, 20480
  s_add_u32 s13, s8, 262144
  buffer_load_dwordx4 v200, s[36:39], s13 offen offset:0  lds
  ds_read_b64_tr_b16 v[62:63], v206 offset:4608
  v_mfma_f32_32x32x16_bf16 v[136:151], v[76:79], v[80:83], v[136:151]
  buffer_load_dwordx4 v201, s[36:39], s13 offen offset:1024  lds
  ds_read_b128 v[64:67], v213 offset:0
  v_mfma_f32_32x32x16_bf16 v[152:167], v[76:79], v[84:87], v[152:167]
  buffer_load_dwordx4 v202, s[36:39], s13 offen offset:2048  lds
  ds_read_b128 v[68:71], v213 offset:4096
  s_waitcnt lgkmcnt(6)
  v_mfma_f32_32x32x16_bf16 v[104:119], v[40:43], v[48:51], v[104:119]
  ds_read_b64_tr_b16 v[72:73], v205 offset:6144
  ds_read_b64_tr_b16 v[74:75], v205 offset:6656
  ds_read_b64_tr_b16 v[76:77], v206 offset:6144
  v_mfma_f32_32x32x16_bf16 v[120:135], v[40:43], v[52:55], v[120:135]
  buffer_load_dwordx4 v203, s[36:39], s13 offen offset:3072  lds
  ds_read_b64_tr_b16 v[78:79], v206 offset:6656
  v_mfma_f32_32x32x16_bf16 v[136:151], v[44:47], v[48:51], v[136:151]
  s_lshr_b32 s13, s8, 12
  s_add_u32 s13, s13, s59
  s_add_u32 m0, s60, 131072
  s_add_u32 s14, s13, 36864
  buffer_load_dwordx4 v204, s[32:35], s13 offen  lds
  ds_read_b128 v[80:83], v214 offset:0
  v_mfma_f32_32x32x16_bf16 v[152:167], v[44:47], v[52:55], v[152:167]
  s_add_u32 m0, s60, 135168
  s_nop 0
  buffer_load_dwordx4 v204, s[32:35], s14 offen  lds
  ds_read_b128 v[84:87], v214 offset:4096
  s_waitcnt vmcnt(14)
  s_barrier
  v_add_u32 v211, 155648, v207
  v_add_u32 v212, 155648, v208
  v_add_u32 v213, 155648, v209
  v_add_u32 v214, 155648, v210
  s_waitcnt lgkmcnt(6)
  v_mfma_f32_32x32x16_bf16 v[104:119], v[56:59], v[64:67], v[104:119]
  ds_read_b64_tr_b16 v[40:41], v205 offset:8192
  ds_read_b64_tr_b16 v[42:43], v205 offset:8704
  ds_read_b64_tr_b16 v[44:45], v206 offset:8192
  v_mfma_f32_32x32x16_bf16 v[120:135], v[56:59], v[68:71], v[120:135]
  s_add_u32 m0, s47, 24576
  s_nop 0
  buffer_load_dwordx4 v200, s[36:39], s11 offen offset:0  lds
  ds_read_b64_tr_b16 v[46:47], v206 offset:8704
  v_mfma_f32_32x32x16_bf16 v[136:151], v[60:63], v[64:67], v[136:151]
  buffer_load_dwordx4 v201, s[36:39], s11 offen offset:1024  lds
  ds_read_b128 v[48:51], v211 offset:0
  v_mfma_f32_32x32x16_bf16 v[152:167], v[60:63], v[68:71], v[152:167]
  buffer_load_dwordx4 v202, s[36:39], s11 offen offset:2048  lds
  ds_read_b128 v[52:55], v211 offset:4096
  s_waitcnt lgkmcnt(6)
  v_mfma_f32_32x32x16_bf16 v[104:119], v[72:75], v[80:83], v[104:119]
  ds_read_b64_tr_b16 v[56:57], v205 offset:10240
  ds_read_b64_tr_b16 v[58:59], v205 offset:10752
  ds_read_b64_tr_b16 v[60:61], v206 offset:10240
  v_mfma_f32_32x32x16_bf16 v[120:135], v[72:75], v[84:87], v[120:135]
  buffer_load_dwordx4 v203, s[36:39], s11 offen offset:3072  lds
  ds_read_b64_tr_b16 v[62:63], v206 offset:10752
  v_mfma_f32_32x32x16_bf16 v[136:151], v[76:79], v[80:83], v[136:151]
  s_add_u32 m0, s47, 28672
  s_add_u32 s13, s11, 262144
  buffer_load_dwordx4 v200, s[36:39], s13 offen offset:0  lds
  ds_read_b128 v[64:67], v212 offset:0
  v_mfma_f32_32x32x16_bf16 v[152:167], v[76:79], v[84:87], v[152:167]
  buffer_load_dwordx4 v201, s[36:39], s13 offen offset:1024  lds
  ds_read_b128 v[68:71], v212 offset:4096
  s_waitcnt vmcnt(16)
  s_waitcnt lgkmcnt(6)
  v_mfma_f32_32x32x16_bf16 v[104:119], v[40:43], v[48:51], v[104:119]
  ds_read_b64_tr_b16 v[72:73], v205 offset:12288
  ds_read_b64_tr_b16 v[74:75], v205 offset:12800
  ds_read_b64_tr_b16 v[76:77], v206 offset:12288
  v_mfma_f32_32x32x16_bf16 v[120:135], v[40:43], v[52:55], v[120:135]
  buffer_load_dwordx4 v202, s[36:39], s13 offen offset:2048  lds
  ds_read_b64_tr_b16 v[78:79], v206 offset:12800
  v_mfma_f32_32x32x16_bf16 v[136:151], v[44:47], v[48:51], v[136:151]
  buffer_load_dwordx4 v203, s[36:39], s13 offen offset:3072  lds
  ds_read_b128 v[80:83], v213 offset:0
  v_mfma_f32_32x32x16_bf16 v[152:167], v[44:47], v[52:55], v[152:167]
  s_add_u32 m0, s47, 0
  s_nop 0
  buffer_load_dwordx4 v200, s[36:39], s9 offen offset:0  lds
  ds_read_b128 v[84:87], v213 offset:4096
  s_waitcnt lgkmcnt(6)
  v_mfma_f32_32x32x16_bf16 v[104:119], v[56:59], v[64:67], v[104:119]
  ds_read_b64_tr_b16 v[40:41], v205 offset:14336
  ds_read_b64_tr_b16 v[42:43], v205 offset:14848
  ds_read_b64_tr_b16 v[44:45], v206 offset:14336
  v_mfma_f32_32x32x16_bf16 v[120:135], v[56:59], v[68:71], v[120:135]
  buffer_load_dwordx4 v201, s[36:39], s9 offen offset:1024  lds
  ds_read_b64_tr_b16 v[46:47], v206 offset:14848
  v_mfma_f32_32x32x16_bf16 v[136:151], v[60:63], v[64:67], v[136:151]
  buffer_load_dwordx4 v202, s[36:39], s9 offen offset:2048  lds
  ds_read_b128 v[48:51], v214 offset:0
  v_mfma_f32_32x32x16_bf16 v[152:167], v[60:63], v[68:71], v[152:167]
  buffer_load_dwordx4 v203, s[36:39], s9 offen offset:3072  lds
  ds_read_b128 v[52:55], v214 offset:4096
  s_waitcnt vmcnt(12)
  s_barrier
  v_add_u32 v211, 131072, v207
  v_add_u32 v212, 131072, v208
  v_add_u32 v213, 131072, v209
  v_add_u32 v214, 131072, v210
  s_waitcnt lgkmcnt(6)
  v_mfma_f32_32x32x16_bf16 v[104:119], v[72:75], v[80:83], v[104:119]
  ds_read_b64_tr_b16 v[56:57], v205 offset:16384
  ds_read_b64_tr_b16 v[58:59], v205 offset:16896
  ds_read_b64_tr_b16 v[60:61], v206 offset:16384
  v_mfma_f32_32x32x16_bf16 v[120:135], v[72:75], v[84:87], v[120:135]
  s_lshr_b32 s13, s9, 12
  s_add_u32 s13, s13, s59
  s_add_u32 m0, s60, 139264
  s_add_u32 s14, s13, 36864
  buffer_load_dwordx4 v204, s[32:35], s13 offen  lds
  ds_read_b64_tr_b16 v[62:63], v206 offset:16896
  v_mfma_f32_32x32x16_bf16 v[136:151], v[76:79], v[80:83], v[136:151]
  s_add_u32 m0, s60, 143360
  s_nop 0
  buffer_load_dwordx4 v204, s[32:35], s14 offen  lds
  ds_read_b128 v[64:67], v211 offset:0
  v_mfma_f32_32x32x16_bf16 v[152:167], v[76:79], v[84:87], v[152:167]
  s_add_u32 m0, s47, 4096
  s_add_u32 s13, s9, 262144
  buffer_load_dwordx4 v200, s[36:39], s13 offen offset:0  lds
  ds_read_b128 v[68:71], v211 offset:4096
  s_waitcnt lgkmcnt(6)
  v_mfma_f32_32x32x16_bf16 v[104:119], v[40:43], v[48:51], v[104:119]
  ds_read_b64_tr_b16 v[72:73], v205 offset:18432
  ds_read_b64_tr_b16 v[74:75], v205 offset:18944
  ds_read_b64_tr_b16 v[76:77], v206 offset:18432
  v_mfma_f32_32x32x16_bf16 v[120:135], v[40:43], v[52:55], v[120:135]
  buffer_load_dwordx4 v201, s[36:39], s13 offen offset:1024  lds
  ds_read_b64_tr_b16 v[78:79], v206 offset:18944
  v_mfma_f32_32x32x16_bf16 v[136:151], v[44:47], v[48:51], v[136:151]
  buffer_load_dwordx4 v202, s[36:39], s13 offen offset:2048  lds
  ds_read_b128 v[80:83], v212 offset:0
  v_mfma_f32_32x32x16_bf16 v[152:167], v[44:47], v[52:55], v[152:167]
  buffer_load_dwordx4 v203, s[36:39], s13 offen offset:3072  lds
  ds_read_b128 v[84:87], v212 offset:4096
  s_waitcnt lgkmcnt(6)
  v_mfma_f32_32x32x16_bf16 v[104:119], v[56:59], v[64:67], v[104:119]
  ds_read_b64_tr_b16 v[40:41], v205 offset:20480
  ds_read_b64_tr_b16 v[42:43], v205 offset:20992
  ds_read_b64_tr_b16 v[44:45], v206 offset:20480
  v_mfma_f32_32x32x16_bf16 v[120:135], v[56:59], v[68:71], v[120:135]
  s_add_u32 m0, s47, 8192
  s_nop 0
  buffer_load_dwordx4 v200, s[36:39], s10 offen offset:0  lds
  ds_read_b64_tr_b16 v[46:47], v206 offset:20992
  v_mfma_f32_32x32x16_bf16 v[136:151], v[60:63], v[64:67], v[136:151]
  buffer_load_dwordx4 v201, s[36:39], s10 offen offset:1024  lds
  ds_read_b128 v[48:51], v213 offset:0
  v_mfma_f32_32x32x16_bf16 v[152:167], v[60:63], v[68:71], v[152:167]
  buffer_load_dwordx4 v202, s[36:39], s10 offen offset:2048  lds
  ds_read_b128 v[52:55], v213 offset:4096
  s_waitcnt lgkmcnt(6)
  v_mfma_f32_32x32x16_bf16 v[104:119], v[72:75], v[80:83], v[104:119]
  ds_read_b64_tr_b16 v[56:57], v205 offset:22528
  ds_read_b64_tr_b16 v[58:59], v205 offset:23040
  ds_read_b64_tr_b16 v[60:61], v206 offset:22528
  v_mfma_f32_32x32x16_bf16 v[120:135], v[72:75], v[84:87], v[120:135]
  buffer_load_dwordx4 v203, s[36:39], s10 offen offset:3072  lds
  ds_read_b64_tr_b16 v[62:63], v206 offset:23040
  v_mfma_f32_32x32x16_bf16 v[136:151], v[76:79], v[80:83], v[136:151]
  s_lshr_b32 s13, s10, 12
  s_add_u32 s13, s13, s59
  s_add_u32 m0, s60, 147456
  s_add_u32 s14, s13, 36864
  buffer_load_dwordx4 v204, s[32:35], s13 offen  lds
  ds_read_b128 v[64:67], v214 offset:0
  v_mfma_f32_32x32x16_bf16 v[152:167], v[76:79], v[84:87], v[152:167]
  s_add_u32 m0, s60, 151552
  s_nop 0
  buffer_load_dwordx4 v204, s[32:35], s14 offen  lds
  ds_read_b128 v[68:71], v214 offset:4096
  s_waitcnt vmcnt(10)
  s_barrier
  v_add_u32 v211, 139264, v207
  v_add_u32 v212, 139264, v208
  v_add_u32 v213, 139264, v209
  v_add_u32 v214, 139264, v210
  s_waitcnt lgkmcnt(6)
  v_mfma_f32_32x32x16_bf16 v[104:119], v[40:43], v[48:51], v[104:119]
  ds_read_b64_tr_b16 v[72:73], v205 offset:0
  ds_read_b64_tr_b16 v[74:75], v205 offset:512
  ds_read_b64_tr_b16 v[76:77], v206 offset:0
  v_mfma_f32_32x32x16_bf16 v[120:135], v[40:43], v[52:55], v[120:135]
  s_add_u32 m0, s47, 12288
  s_add_u32 s13, s10, 262144
  buffer_load_dwordx4 v200, s[36:39], s13 offen offset:0  lds
  ds_read_b64_tr_b16 v[78:79], v206 offset:512
  v_mfma_f32_32x32x16_bf16 v[136:151], v[44:47], v[48:51], v[136:151]
  buffer_load_dwordx4 v201, s[36:39], s13 offen offset:1024  lds
  ds_read_b128 v[80:83], v211 offset:0
  v_mfma_f32_32x32x16_bf16 v[152:167], v[44:47], v[52:55], v[152:167]
  buffer_load_dwordx4 v202, s[36:39], s13 offen offset:2048  lds
  ds_read_b128 v[84:87], v211 offset:4096
  s_waitcnt lgkmcnt(6)
  v_mfma_f32_32x32x16_bf16 v[104:119], v[56:59], v[64:67], v[104:119]
  ds_read_b64_tr_b16 v[40:41], v205 offset:2048
  ds_read_b64_tr_b16 v[42:43], v205 offset:2560
  ds_read_b64_tr_b16 v[44:45], v206 offset:2048
  v_mfma_f32_32x32x16_bf16 v[120:135], v[56:59], v[68:71], v[120:135]
  buffer_load_dwordx4 v203, s[36:39], s13 offen offset:3072  lds
  ds_read_b64_tr_b16 v[46:47], v206 offset:2560
  v_mfma_f32_32x32x16_bf16 v[136:151], v[60:63], v[64:67], v[136:151]
  s_add_u32 m0, s47, 16384
  s_nop 0
  buffer_load_dwordx4 v200, s[36:39], s12 offen offset:0  lds
  ds_read_b128 v[48:51], v212 offset:0
  v_mfma_f32_32x32x16_bf16 v[152:167], v[60:63], v[68:71], v[152:167]
  buffer_load_dwordx4 v201, s[36:39], s12 offen offset:1024  lds
  ds_read_b128 v[52:55], v212 offset:4096
  s_waitcnt vmcnt(12)
  s_waitcnt lgkmcnt(6)
  v_mfma_f32_32x32x16_bf16 v[104:119], v[72:75], v[80:83], v[104:119]
  ds_read_b64_tr_b16 v[56:57], v205 offset:4096
  ds_read_b64_tr_b16 v[58:59], v205 offset:4608
  ds_read_b64_tr_b16 v[60:61], v206 offset:4096
  v_mfma_f32_32x32x16_bf16 v[120:135], v[72:75], v[84:87], v[120:135]
  buffer_load_dwordx4 v202, s[36:39], s12 offen offset:2048  lds
  ds_read_b64_tr_b16 v[62:63], v206 offset:4608
  v_mfma_f32_32x32x16_bf16 v[136:151], v[76:79], v[80:83], v[136:151]
  buffer_load_dwordx4 v203, s[36:39], s12 offen offset:3072  lds
  ds_read_b128 v[64:67], v213 offset:0
  v_mfma_f32_32x32x16_bf16 v[152:167], v[76:79], v[84:87], v[152:167]
  s_lshr_b32 s13, s11, 12
  s_add_u32 s13, s13, s59
  s_add_u32 m0, s60, 155648
  s_add_u32 s14, s13, 36864
  buffer_load_dwordx4 v204, s[32:35], s13 offen  lds
  ds_read_b128 v[68:71], v213 offset:4096
  s_waitcnt lgkmcnt(6)
  v_mfma_f32_32x32x16_bf16 v[104:119], v[40:43], v[48:51], v[104:119]
  ds_read_b64_tr_b16 v[72:73], v205 offset:6144
  ds_read_b64_tr_b16 v[74:75], v205 offset:6656
  ds_read_b64_tr_b16 v[76:77], v206 offset:6144
  v_mfma_f32_32x32x16_bf16 v[120:135], v[40:43], v[52:55], v[120:135]
  s_add_u32 m0, s60, 159744
  s_nop 0
  buffer_load_dwordx4 v204, s[32:35], s14 offen  lds
  ds_read_b64_tr_b16 v[78:79], v206 offset:6656
  v_mfma_f32_32x32x16_bf16 v[136:151], v[44:47], v[48:51], v[136:151]
  s_add_u32 m0, s47, 20480
  s_add_u32 s13, s12, 262144
  buffer_load_dwordx4 v200, s[36:39], s13 offen offset:0  lds
  ds_read_b128 v[80:83], v214 offset:0
  v_mfma_f32_32x32x16_bf16 v[152:167], v[44:47], v[52:55], v[152:167]
  buffer_load_dwordx4 v201, s[36:39], s13 offen offset:1024  lds
  ds_read_b128 v[84:87], v214 offset:4096
  s_waitcnt vmcnt(12)
  s_barrier
  v_add_u32 v211, 147456, v207
  v_add_u32 v212, 147456, v208
  v_add_u32 v213, 147456, v209
  v_add_u32 v214, 147456, v210
  s_waitcnt lgkmcnt(6)
  v_mfma_f32_32x32x16_bf16 v[104:119], v[56:59], v[64:67], v[104:119]
  ds_read_b64_tr_b16 v[40:41], v205 offset:8192
  ds_read_b64_tr_b16 v[42:43], v205 offset:8704
  ds_read_b64_tr_b16 v[44:45], v206 offset:8192
  v_mfma_f32_32x32x16_bf16 v[120:135], v[56:59], v[68:71], v[120:135]
  buffer_load_dwordx4 v202, s[36:39], s13 offen offset:2048  lds
  ds_read_b64_tr_b16 v[46:47], v206 offset:8704
  v_mfma_f32_32x32x16_bf16 v[136:151], v[60:63], v[64:67], v[136:151]
  buffer_load_dwordx4 v203, s[36:39], s13 offen offset:3072  lds
  ds_read_b128 v[48:51], v211 offset:0
  v_mfma_f32_32x32x16_bf16 v[152:167], v[60:63], v[68:71], v[152:167]
  s_lshr_b32 s13, s12, 12
  s_add_u32 s13, s13, s59
  s_add_u32 m0, s60, 131072
  s_add_u32 s14, s13, 36864
  buffer_load_dwordx4 v204, s[32:35], s13 offen  lds
  ds_read_b128 v[52:55], v211 offset:4096
  s_waitcnt lgkmcnt(6)
  v_mfma_f32_32x32x16_bf16 v[104:119], v[72:75], v[80:83], v[104:119]
  ds_read_b64_tr_b16 v[56:57], v205 offset:10240
  ds_read_b64_tr_b16 v[58:59], v205 offset:10752
  ds_read_b64_tr_b16 v[60:61], v206 offset:10240
  v_mfma_f32_32x32x16_bf16 v[120:135], v[72:75], v[84:87], v[120:135]
  s_add_u32 m0, s60, 135168
  s_nop 0
  buffer_load_dwordx4 v204, s[32:35], s14 offen  lds
  ds_read_b64_tr_b16 v[62:63], v206 offset:10752
  v_mfma_f32_32x32x16_bf16 v[136:151], v[76:79], v[80:83], v[136:151]
  s_add_u32 m0, s47, 0
  s_add_u32 s50, s48, 0
  buffer_load_dwordx4 v2, s[24:27], s50 offen offset:0 nt lds
  ds_read_b128 v[64:67], v212 offset:0
  v_mfma_f32_32x32x16_bf16 v[152:167], v[76:79], v[84:87], v[152:167]
  buffer_load_dwordx4 v3, s[24:27], s50 offen offset:1024 nt lds
  ds_read_b128 v[68:71], v212 offset:4096
  s_waitcnt vmcnt(14)
  s_waitcnt lgkmcnt(6)
  v_mfma_f32_32x32x16_bf16 v[104:119], v[40:43], v[48:51], v[104:119]
  ds_read_b64_tr_b16 v[72:73], v205 offset:12288
  ds_read_b64_tr_b16 v[74:75], v205 offset:12800
  ds_read_b64_tr_b16 v[76:77], v206 offset:12288
  v_mfma_f32_32x32x16_bf16 v[120:135], v[40:43], v[52:55], v[120:135]
  buffer_load_dwordx4 v4, s[24:27], s50 offen offset:2048 nt lds
  ds_read_b64_tr_b16 v[78:79], v206 offset:12800
  v_mfma_f32_32x32x16_bf16 v[136:151], v[44:47], v[48:51], v[136:151]
  buffer_load_dwordx4 v5, s[24:27], s50 offen offset:3072 nt lds
  ds_read_b128 v[80:83], v213 offset:0
  v_mfma_f32_32x32x16_bf16 v[152:167], v[44:47], v[52:55], v[152:167]
  s_add_u32 m0, s47, 4096
  s_add_u32 s50, s48, 8192
  buffer_load_dwordx4 v2, s[24:27], s50 offen offset:0 nt lds
  ds_read_b128 v[84:87], v213 offset:4096
  s_waitcnt lgkmcnt(6)
  v_mfma_f32_32x32x16_bf16 v[104:119], v[56:59], v[64:67], v[104:119]
  ds_read_b64_tr_b16 v[40:41], v205 offset:14336
  ds_read_b64_tr_b16 v[42:43], v205 offset:14848
  ds_read_b64_tr_b16 v[44:45], v206 offset:14336
  v_mfma_f32_32x32x16_bf16 v[120:135], v[56:59], v[68:71], v[120:135]
  buffer_load_dwordx4 v3, s[24:27], s50 offen offset:1024 nt lds
  ds_read_b64_tr_b16 v[46:47], v206 offset:14848
  v_mfma_f32_32x32x16_bf16 v[136:151], v[60:63], v[64:67], v[136:151]
  buffer_load_dwordx4 v4, s[24:27], s50 offen offset:2048 nt lds
  ds_read_b128 v[48:51], v214 offset:0
  v_mfma_f32_32x32x16_bf16 v[152:167], v[60:63], v[68:71], v[152:167]
  buffer_load_dwordx4 v5, s[24:27], s50 offen offset:3072 nt lds
  ds_read_b128 v[52:55], v214 offset:4096
  s_waitcnt vmcnt(14)
  s_barrier
  v_add_u32 v211, 155648, v207
  v_add_u32 v212, 155648, v208
  v_add_u32 v213, 155648, v209
  v_add_u32 v214, 155648, v210
  s_waitcnt lgkmcnt(6)
  v_mfma_f32_32x32x16_bf16 v[104:119], v[72:75], v[80:83], v[104:119]
  ds_read_b64_tr_b16 v[56:57], v205 offset:24576
  ds_read_b64_tr_b16 v[58:59], v205 offset:25088
  ds_read_b64_tr_b16 v[60:61], v206 offset:24576
  v_mfma_f32_32x32x16_bf16 v[120:135], v[72:75], v[84:87], v[120:135]
  ds_read_b64_tr_b16 v[62:63], v206 offset:25088
  v_mfma_f32_32x32x16_bf16 v[136:151], v[76:79], v[80:83], v[136:151]
  ds_read_b128 v[64:67], v211 offset:0
  v_mfma_f32_32x32x16_bf16 v[152:167], v[76:79], v[84:87], v[152:167]
  ds_read_b128 v[68:71], v211 offset:4096
  s_waitcnt lgkmcnt(6)
  v_mfma_f32_32x32x16_bf16 v[104:119], v[40:43], v[48:51], v[104:119]
  ds_read_b64_tr_b16 v[72:73], v205 offset:26624
  ds_read_b64_tr_b16 v[74:75], v205 offset:27136
  ds_read_b64_tr_b16 v[76:77], v206 offset:26624
  v_mfma_f32_32x32x16_bf16 v[120:135], v[40:43], v[52:55], v[120:135]
  s_add_u32 m0, s47, 8192
  s_add_u32 s50, s48, 0
  buffer_load_dwordx4 v2, s[28:31], s50 offen offset:0 nt lds
  ds_read_b64_tr_b16 v[78:79], v206 offset:27136
  v_mfma_f32_32x32x16_bf16 v[136:151], v[44:47], v[48:51], v[136:151]
  buffer_load_dwordx4 v3, s[28:31], s50 offen offset:1024 nt lds
  ds_read_b128 v[80:83], v212 offset:0
  v_mfma_f32_32x32x16_bf16 v[152:167], v[44:47], v[52:55], v[152:167]
  buffer_load_dwordx4 v4, s[28:31], s50 offen offset:2048 nt lds
  ds_read_b128 v[84:87], v212 offset:4096
  s_waitcnt lgkmcnt(6)
  v_mfma_f32_32x32x16_bf16 v[104:119], v[56:59], v[64:67], v[104:119]
  ds_read_b64_tr_b16 v[40:41], v205 offset:28672
  ds_read_b64_tr_b16 v[42:43], v205 offset:29184
  ds_read_b64_tr_b16 v[44:45], v206 offset:28672
  v_mfma_f32_32x32x16_bf16 v[120:135], v[56:59], v[68:71], v[120:135]
  buffer_load_dwordx4 v5, s[28:31], s50 offen offset:3072 nt lds
  ds_read_b64_tr_b16 v[46:47], v206 offset:29184
  v_mfma_f32_32x32x16_bf16 v[136:151], v[60:63], v[64:67], v[136:151]
  s_add_u32 m0, s47, 12288
  s_add_u32 s50, s48, 8192
  buffer_load_dwordx4 v2, s[28:31], s50 offen offset:0 nt lds
  ds_read_b128 v[48:51], v213 offset:0
  v_mfma_f32_32x32x16_bf16 v[152:167], v[60:63], v[68:71], v[152:167]
  buffer_load_dwordx4 v3, s[28:31], s50 offen offset:1024 nt lds
  ds_read_b128 v[52:55], v213 offset:4096
  s_waitcnt lgkmcnt(6)
  v_mfma_f32_32x32x16_bf16 v[104:119], v[72:75], v[80:83], v[104:119]
  ds_read_b64_tr_b16 v[56:57], v205 offset:30720
  ds_read_b64_tr_b16 v[58:59], v205 offset:31232
  ds_read_b64_tr_b16 v[60:61], v206 offset:30720
  v_mfma_f32_32x32x16_bf16 v[120:135], v[72:75], v[84:87], v[120:135]
  buffer_load_dwordx4 v4, s[28:31], s50 offen offset:2048 nt lds
  ds_read_b64_tr_b16 v[62:63], v206 offset:31232
  v_mfma_f32_32x32x16_bf16 v[136:151], v[76:79], v[80:83], v[136:151]
  buffer_load_dwordx4 v5, s[28:31], s50 offen offset:3072 nt lds
  ds_read_b128 v[64:67], v214 offset:0
  v_mfma_f32_32x32x16_bf16 v[152:167], v[76:79], v[84:87], v[152:167]
  ds_read_b128 v[68:71], v214 offset:4096
  s_waitcnt vmcnt(16)
  s_barrier
  v_add_u32 v211, 131072, v207
  v_add_u32 v212, 131072, v208
  v_add_u32 v213, 131072, v209
  v_add_u32 v214, 131072, v210
  s_waitcnt lgkmcnt(6)
  v_mfma_f32_32x32x16_bf16 v[104:119], v[40:43], v[48:51], v[104:119]
  ds_read_b64_tr_b16 v[72:73], v205 offset:16384
  ds_read_b64_tr_b16 v[74:75], v205 offset:16896
  ds_read_b64_tr_b16 v[76:77], v206 offset:16384
  v_mfma_f32_32x32x16_bf16 v[120:135], v[40:43], v[52:55], v[120:135]
  ds_read_b64_tr_b16 v[78:79], v206 offset:16896
  v_mfma_f32_32x32x16_bf16 v[136:151], v[44:47], v[48:51], v[136:151]
  ds_read_b128 v[80:83], v211 offset:0
  v_mfma_f32_32x32x16_bf16 v[152:167], v[44:47], v[52:55], v[152:167]
  ds_read_b128 v[84:87], v211 offset:4096
  s_waitcnt lgkmcnt(6)
  v_mfma_f32_32x32x16_bf16 v[104:119], v[56:59], v[64:67], v[104:119]
  ds_read_b64_tr_b16 v[40:41], v205 offset:18432
  ds_read_b64_tr_b16 v[42:43], v205 offset:18944
  ds_read_b64_tr_b16 v[44:45], v206 offset:18432
  v_mfma_f32_32x32x16_bf16 v[120:135], v[56:59], v[68:71], v[120:135]
  ds_read_b64_tr_b16 v[46:47], v206 offset:18944
  v_mfma_f32_32x32x16_bf16 v[136:151], v[60:63], v[64:67], v[136:151]
  ds_read_b128 v[48:51], v212 offset:0
  v_mfma_f32_32x32x16_bf16 v[152:167], v[60:63], v[68:71], v[152:167]
  ds_read_b128 v[52:55], v212 offset:4096
  s_waitcnt lgkmcnt(6)
  v_mfma_f32_32x32x16_bf16 v[104:119], v[72:75], v[80:83], v[104:119]
  ds_read_b64_tr_b16 v[56:57], v205 offset:20480
  ds_read_b64_tr_b16 v[58:59], v205 offset:20992
  ds_read_b64_tr_b16 v[60:61], v206 offset:20480
  v_mfma_f32_32x32x16_bf16 v[120:135], v[72:75], v[84:87], v[120:135]
  ds_read_b64_tr_b16 v[62:63], v206 offset:20992
  v_mfma_f32_32x32x16_bf16 v[136:151], v[76:79], v[80:83], v[136:151]
  ds_read_b128 v[64:67], v213 offset:0
  v_mfma_f32_32x32x16_bf16 v[152:167], v[76:79], v[84:87], v[152:167]
  ds_read_b128 v[68:71], v213 offset:4096
  s_waitcnt lgkmcnt(6)
  v_mfma_f32_32x32x16_bf16 v[104:119], v[40:43], v[48:51], v[104:119]
  ds_read_b64_tr_b16 v[72:73], v205 offset:22528
  ds_read_b64_tr_b16 v[74:75], v205 offset:23040
  ds_read_b64_tr_b16 v[76:77], v206 offset:22528
  v_mfma_f32_32x32x16_bf16 v[120:135], v[40:43], v[52:55], v[120:135]
  ds_read_b64_tr_b16 v[78:79], v206 offset:23040
  v_mfma_f32_32x32x16_bf16 v[136:151], v[44:47], v[48:51], v[136:151]
  ds_read_b128 v[80:83], v214 offset:0
  v_mfma_f32_32x32x16_bf16 v[152:167], v[44:47], v[52:55], v[152:167]
  ds_read_b128 v[84:87], v214 offset:4096
  s_waitcnt lgkmcnt(6)
  v_mfma_f32_32x32x16_bf16 v[104:119], v[56:59], v[64:67], v[104:119]
  v_mfma_f32_32x32x16_bf16 v[120:135], v[56:59], v[68:71], v[120:135]
  v_mfma_f32_32x32x16_bf16 v[136:151], v[60:63], v[64:67], v[136:151]
  v_mfma_f32_32x32x16_bf16 v[152:167], v[60:63], v[68:71], v[152:167]
  s_waitcnt lgkmcnt(0)
  v_mfma_f32_32x32x16_bf16 v[104:119], v[72:75], v[80:83], v[104:119]
  v_mfma_f32_32x32x16_bf16 v[120:135], v[72:75], v[84:87], v[120:135]
  v_mfma_f32_32x32x16_bf16 v[136:151], v[76:79], v[80:83], v[136:151]
  v_mfma_f32_32x32x16_bf16 v[152:167], v[76:79], v[84:87], v[152:167]
  s_nop 7
  s_nop 5
  v_lshlrev_b32 v30, 4, v1
  v_add_u32 v31, s47, v30
  v_add_u32 v31, 24576, v31
  s_lshl_b32 s51, s45, 15
  v_add_u32 v32, s51, v30
  v_add_u32 v32, 24576, v32
  v_add_u32 v33, 65536, v32
  v_cvt_pk_bf16_f32 v168, v104, v105
  v_cvt_pk_bf16_f32 v169, v106, v107
  v_cvt_pk_bf16_f32 v170, v108, v109
  v_cvt_pk_bf16_f32 v171, v110, v111
  v_cvt_pk_bf16_f32 v176, v112, v113
  v_cvt_pk_bf16_f32 v177, v114, v115
  v_cvt_pk_bf16_f32 v178, v116, v117
  v_cvt_pk_bf16_f32 v179, v118, v119
  v_cvt_pk_bf16_f32 v172, v120, v121
  v_cvt_pk_bf16_f32 v173, v122, v123
  v_cvt_pk_bf16_f32 v174, v124, v125
  v_cvt_pk_bf16_f32 v175, v126, v127
  v_cvt_pk_bf16_f32 v180, v128, v129
  v_cvt_pk_bf16_f32 v181, v130, v131
  v_cvt_pk_bf16_f32 v182, v132, v133
  v_cvt_pk_bf16_f32 v183, v134, v135
  v_cvt_pk_bf16_f32 v184, v136, v137
  v_cvt_pk_bf16_f32 v185, v138, v139
  v_cvt_pk_bf16_f32 v186, v140, v141
  v_cvt_pk_bf16_f32 v187, v142, v143
  v_cvt_pk_bf16_f32 v192, v144, v145
  v_cvt_pk_bf16_f32 v193, v146, v147
  v_cvt_pk_bf16_f32 v194, v148, v149
  v_cvt_pk_bf16_f32 v195, v150, v151
  v_cvt_pk_bf16_f32 v188, v152, v153
  v_cvt_pk_bf16_f32 v189, v154, v155
  v_cvt_pk_bf16_f32 v190, v156, v157
  v_cvt_pk_bf16_f32 v191, v158, v159
  v_cvt_pk_bf16_f32 v196, v160, v161
  v_cvt_pk_bf16_f32 v197, v162, v163
  v_cvt_pk_bf16_f32 v198, v164, v165
  v_cvt_pk_bf16_f32 v199, v166, v167
  ds_write_b128 v31, v[168:171] offset:0
  ds_write_b128 v31, v[172:175] offset:1024
  ds_write_b128 v31, v[176:179] offset:2048
  ds_write_b128 v31, v[180:183] offset:3072
  ds_write_b128 v31, v[184:187] offset:4096
  ds_write_b128 v31, v[188:191] offset:5120
  ds_write_b128 v31, v[192:195] offset:6144
  ds_write_b128 v31, v[196:199] offset:7168
  s_waitcnt lgkmcnt(0)
  s_barrier
  ds_read_b128 v[40:43], v32 offset:0
  ds_read_b128 v[72:75], v32 offset:1024
  ds_read_b128 v[44:47], v32 offset:2048
  ds_read_b128 v[76:79], v32 offset:3072
  ds_read_b128 v[48:51], v32 offset:4096
  ds_read_b128 v[80:83], v32 offset:5120
  ds_read_b128 v[52:55], v32 offset:6144
  ds_read_b128 v[84:87], v32 offset:7168
  s_waitcnt lgkmcnt(0)
  ds_read_b128 v[56:59], v33 offset:0
  ds_read_b128 v[88:91], v33 offset:1024
  ds_read_b128 v[60:63], v33 offset:2048
  ds_read_b128 v[92:95], v33 offset:3072
  ds_read_b128 v[64:67], v33 offset:4096
  ds_read_b128 v[96:99], v33 offset:5120
  ds_read_b128 v[68:71], v33 offset:6144
  ds_read_b128 v[100:103], v33 offset:7168
  s_waitcnt lgkmcnt(0)
  s_add_u32 s48, s48, 16384
  s_waitcnt vmcnt(8)
  ds_read_b128 v[136:139], v6 offset:0
  ds_read_b128 v[140:143], v7 offset:0
  ds_read_b128 v[144:147], v8 offset:0
  ds_read_b128 v[148:151], v9 offset:0
  ds_read_b128 v[152:155], v10 offset:0
  ds_read_b128 v[156:159], v11 offset:0
  ds_read_b128 v[160:163], v12 offset:0
  ds_read_b128 v[164:167], v13 offset:0
  s_waitcnt lgkmcnt(7)
  v_mfma_f32_32x32x16_bf16 v[104:119], v[136:139], v[40:43], 0
  v_mfma_f32_32x32x16_bf16 v[120:135], v[136:139], v[72:75], 0
  s_waitcnt lgkmcnt(6)
  v_mfma_f32_32x32x16_bf16 v[104:119], v[140:143], v[44:47], v[104:119]
  v_mfma_f32_32x32x16_bf16 v[120:135], v[140:143], v[76:79], v[120:135]
  s_waitcnt lgkmcnt(5)
  v_mfma_f32_32x32x16_bf16 v[104:119], v[144:147], v[48:51], v[104:119]
  v_mfma_f32_32x32x16_bf16 v[120:135], v[144:147], v[80:83], v[120:135]
  s_waitcnt lgkmcnt(4)
  v_mfma_f32_32x32x16_bf16 v[104:119], v[148:151], v[52:55], v[104:119]
  v_mfma_f32_32x32x16_bf16 v[120:135], v[148:151], v[84:87], v[120:135]
  s_waitcnt lgkmcnt(3)
  v_mfma_f32_32x32x16_bf16 v[104:119], v[152:155], v[56:59], v[104:119]
  v_mfma_f32_32x32x16_bf16 v[120:135], v[152:155], v[88:91], v[120:135]
  s_waitcnt lgkmcnt(2)
  v_mfma_f32_32x32x16_bf16 v[104:119], v[156:159], v[60:63], v[104:119]
  v_mfma_f32_32x32x16_bf16 v[120:135], v[156:159], v[92:95], v[120:135]
  s_waitcnt lgkmcnt(1)
  v_mfma_f32_32x32x16_bf16 v[104:119], v[160:163], v[64:67], v[104:119]
  v_mfma_f32_32x32x16_bf16 v[120:135], v[160:163], v[96:99], v[120:135]
  s_waitcnt lgkmcnt(0)
  v_mfma_f32_32x32x16_bf16 v[104:119], v[164:167], v[68:71], v[104:119]
  v_mfma_f32_32x32x16_bf16 v[120:135], v[164:167], v[100:103], v[120:135]
  s_add_u32 m0, s47, 0
  s_add_u32 s50, s48, 0
  buffer_load_dwordx4 v2, s[24:27], s50 offen offset:0 nt lds
  buffer_load_dwordx4 v3, s[24:27], s50 offen offset:1024 nt lds
  buffer_load_dwordx4 v4, s[24:27], s50 offen offset:2048 nt lds
  buffer_load_dwordx4 v5, s[24:27], s50 offen offset:3072 nt lds
  s_add_u32 m0, s47, 4096
  s_add_u32 s50, s48, 8192
  buffer_load_dwordx4 v2, s[24:27], s50 offen offset:0 nt lds
  buffer_load_dwordx4 v3, s[24:27], s50 offen offset:1024 nt lds
  buffer_load_dwordx4 v4, s[24:27], s50 offen offset:2048 nt lds
  buffer_load_dwordx4 v5, s[24:27], s50 offen offset:3072 nt lds
  s_nop 1
  v_max3_f32 v30, v104, v105, v106
  v_max3_f32 v30, v30, v107, v108
  v_max3_f32 v30, v30, v109, v110
  v_max3_f32 v30, v30, v111, v112
  v_max3_f32 v30, v30, v113, v114
  v_max3_f32 v30, v30, v115, v116
  v_max3_f32 v30, v30, v117, v118
  v_max_f32 v30, v30, v119
  v_max3_f32 v31, v120, v121, v122
  v_max3_f32 v31, v31, v123, v124
  v_max3_f32 v31, v31, v125, v126
  v_max3_f32 v31, v31, v127, v128
  v_max3_f32 v31, v31, v129, v130
  v_max3_f32 v31, v31, v131, v132
  v_max3_f32 v31, v31, v133, v134
  v_max_f32 v31, v31, v135
  v_mov_b32 v32, v30
  v_mov_b32 v33, v31
  s_nop 1
  v_permlane32_swap_b32 v30, v32
  v_permlane32_swap_b32 v31, v33
  s_nop 1
  v_max_f32 v22, v30, v32
  v_max_f32 v23, v31, v33
  v_add_f32 v24, 0x427af233, v22
  v_mul_f32 v38, 0xbe0293ee, v22
  v_add_f32 v25, 0x427af233, v23
  v_mul_f32 v39, 0xbe0293ee, v23
  v_fma_f32 v104, v104, s61, v38
  v_fma_f32 v105, v105, s61, v38
  v_fma_f32 v106, v106, s61, v38
  v_fma_f32 v107, v107, s61, v38
  v_fma_f32 v108, v108, s61, v38
  v_fma_f32 v109, v109, s61, v38
  v_fma_f32 v110, v110, s61, v38
  v_fma_f32 v111, v111, s61, v38
  v_fma_f32 v112, v112, s61, v38
  v_fma_f32 v113, v113, s61, v38
  v_fma_f32 v114, v114, s61, v38
  v_fma_f32 v115, v115, s61, v38
  v_fma_f32 v116, v116, s61, v38
  v_fma_f32 v117, v117, s61, v38
  v_fma_f32 v118, v118, s61, v38
  v_fma_f32 v119, v119, s61, v38
  v_exp_f32 v104, v104
  v_exp_f32 v105, v105
  v_exp_f32 v106, v106
  v_exp_f32 v107, v107
  v_exp_f32 v108, v108
  v_exp_f32 v109, v109
  v_exp_f32 v110, v110
  v_exp_f32 v111, v111
  v_exp_f32 v112, v112
  v_exp_f32 v113, v113
  v_exp_f32 v114, v114
  v_exp_f32 v115, v115
  v_exp_f32 v116, v116
  v_exp_f32 v117, v117
  v_exp_f32 v118, v118
  v_exp_f32 v119, v119
  v_fma_f32 v120, v120, s61, v39
  v_fma_f32 v121, v121, s61, v39
  v_fma_f32 v122, v122, s61, v39
  v_fma_f32 v123, v123, s61, v39
  v_fma_f32 v124, v124, s61, v39
  v_fma_f32 v125, v125, s61, v39
  v_fma_f32 v126, v126, s61, v39
  v_fma_f32 v127, v127, s61, v39
  v_fma_f32 v128, v128, s61, v39
  v_fma_f32 v129, v129, s61, v39
  v_fma_f32 v130, v130, s61, v39
  v_fma_f32 v131, v131, s61, v39
  v_fma_f32 v132, v132, s61, v39
  v_fma_f32 v133, v133, s61, v39
  v_fma_f32 v134, v134, s61, v39
  v_fma_f32 v135, v135, s61, v39
  v_exp_f32 v120, v120
  v_exp_f32 v121, v121
  v_exp_f32 v122, v122
  v_exp_f32 v123, v123
  v_exp_f32 v124, v124
  v_exp_f32 v125, v125
  v_exp_f32 v126, v126
  v_exp_f32 v127, v127
  v_exp_f32 v128, v128
  v_exp_f32 v129, v129
  v_exp_f32 v130, v130
  v_exp_f32 v131, v131
  v_exp_f32 v132, v132
  v_exp_f32 v133, v133
  v_exp_f32 v134, v134
  v_exp_f32 v135, v135
  v_add_f32 v26, v26, v104
  v_add_f32 v27, v27, v105
  v_add_f32 v26, v26, v106
  v_add_f32 v27, v27, v107
  v_add_f32 v26, v26, v108
  v_add_f32 v27, v27, v109
  v_add_f32 v26, v26, v110
  v_add_f32 v27, v27, v111
  v_add_f32 v26, v26, v112
  v_add_f32 v27, v27, v113
  v_add_f32 v26, v26, v114
  v_add_f32 v27, v27, v115
  v_add_f32 v26, v26, v116
  v_add_f32 v27, v27, v117
  v_add_f32 v26, v26, v118
  v_add_f32 v27, v27, v119
  v_cvt_pk_bf16_f32 v200, v104, v105
  v_cvt_pk_bf16_f32 v201, v106, v107
  v_cvt_pk_bf16_f32 v202, v108, v109
  v_cvt_pk_bf16_f32 v203, v110, v111
  v_cvt_pk_bf16_f32 v204, v112, v113
  v_cvt_pk_bf16_f32 v205, v114, v115
  v_cvt_pk_bf16_f32 v206, v116, v117
  v_cvt_pk_bf16_f32 v207, v118, v119
  v_add_f32 v28, v28, v120
  v_add_f32 v29, v29, v121
  v_add_f32 v28, v28, v122
  v_add_f32 v29, v29, v123
  v_add_f32 v28, v28, v124
  v_add_f32 v29, v29, v125
  v_add_f32 v28, v28, v126
  v_add_f32 v29, v29, v127
  v_add_f32 v28, v28, v128
  v_add_f32 v29, v29, v129
  v_add_f32 v28, v28, v130
  v_add_f32 v29, v29, v131
  v_add_f32 v28, v28, v132
  v_add_f32 v29, v29, v133
  v_add_f32 v28, v28, v134
  v_add_f32 v29, v29, v135
  v_cvt_pk_bf16_f32 v208, v120, v121
  v_cvt_pk_bf16_f32 v209, v122, v123
  v_cvt_pk_bf16_f32 v210, v124, v125
  v_cvt_pk_bf16_f32 v211, v126, v127
  v_cvt_pk_bf16_f32 v212, v128, v129
  v_cvt_pk_bf16_f32 v213, v130, v131
  v_cvt_pk_bf16_f32 v214, v132, v133
  v_cvt_pk_bf16_f32 v215, v134, v135
  s_waitcnt vmcnt(8)
  ds_read_b64_tr_b16 v[168:169], v14 offset:8192
  ds_read_b64_tr_b16 v[170:171], v15 offset:8192
  ds_read_b64_tr_b16 v[172:173], v14 offset:12288
  ds_read_b64_tr_b16 v[174:175], v15 offset:12288
  ds_read_b64_tr_b16 v[176:177], v16 offset:8192
  ds_read_b64_tr_b16 v[178:179], v17 offset:8192
  ds_read_b64_tr_b16 v[180:181], v16 offset:12288
  ds_read_b64_tr_b16 v[182:183], v17 offset:12288
  ds_read_b64_tr_b16 v[184:185], v18 offset:8192
  ds_read_b64_tr_b16 v[186:187], v19 offset:8192
  ds_read_b64_tr_b16 v[188:189], v18 offset:12288
  ds_read_b64_tr_b16 v[190:191], v19 offset:12288
  ds_read_b64_tr_b16 v[192:193], v20 offset:8192
  ds_read_b64_tr_b16 v[194:195], v21 offset:8192
  ds_read_b64_tr_b16 v[196:197], v20 offset:12288
  ds_read_b64_tr_b16 v[198:199], v21 offset:12288
  s_waitcnt lgkmcnt(14)
  v_mfma_f32_32x32x16_bf16 a[0:15], v[168:171], v[200:203], a[0:15]
  v_mfma_f32_32x32x16_bf16 a[16:31], v[168:171], v[208:211], a[16:31]
  s_waitcnt lgkmcnt(12)
  v_mfma_f32_32x32x16_bf16 a[0:15], v[172:175], v[204:207], a[0:15]
  v_mfma_f32_32x32x16_bf16 a[16:31], v[172:175], v[212:215], a[16:31]
  s_waitcnt lgkmcnt(10)
  v_mfma_f32_32x32x16_bf16 a[32:47], v[176:179], v[200:203], a[32:47]
  v_mfma_f32_32x32x16_bf16 a[48:63], v[176:179], v[208:211], a[48:63]
  s_waitcnt lgkmcnt(8)
  v_mfma_f32_32x32x16_bf16 a[32:47], v[180:183], v[204:207], a[32:47]
  v_mfma_f32_32x32x16_bf16 a[48:63], v[180:183], v[212:215], a[48:63]
  s_waitcnt lgkmcnt(6)
  v_mfma_f32_32x32x16_bf16 a[64:79], v[184:187], v[200:203], a[64:79]
  v_mfma_f32_32x32x16_bf16 a[80:95], v[184:187], v[208:211], a[80:95]
  s_waitcnt lgkmcnt(4)
  v_mfma_f32_32x32x16_bf16 a[64:79], v[188:191], v[204:207], a[64:79]
  v_mfma_f32_32x32x16_bf16 a[80:95], v[188:191], v[212:215], a[80:95]
  s_waitcnt lgkmcnt(2)
  v_mfma_f32_32x32x16_bf16 a[96:111], v[192:195], v[200:203], a[96:111]
  v_mfma_f32_32x32x16_bf16 a[112:127], v[192:195], v[208:211], a[112:127]
  s_waitcnt lgkmcnt(0)
  v_mfma_f32_32x32x16_bf16 a[96:111], v[196:199], v[204:207], a[96:111]
  v_mfma_f32_32x32x16_bf16 a[112:127], v[196:199], v[212:215], a[112:127]
  s_add_u32 m0, s47, 8192
  s_add_u32 s50, s48, 0
  buffer_load_dwordx4 v2, s[28:31], s50 offen offset:0 nt lds
  buffer_load_dwordx4 v3, s[28:31], s50 offen offset:1024 nt lds
  buffer_load_dwordx4 v4, s[28:31], s50 offen offset:2048 nt lds
  buffer_load_dwordx4 v5, s[28:31], s50 offen offset:3072 nt lds
  s_add_u32 m0, s47, 12288
  s_add_u32 s50, s48, 8192
  buffer_load_dwordx4 v2, s[28:31], s50 offen offset:0 nt lds
  buffer_load_dwordx4 v3, s[28:31], s50 offen offset:1024 nt lds
  buffer_load_dwordx4 v4, s[28:31], s50 offen offset:2048 nt lds
  buffer_load_dwordx4 v5, s[28:31], s50 offen offset:3072 nt lds
  s_add_u32 s48, s48, 16384
  s_mov_b32 s58, 1
L_k1_loop:
  s_waitcnt vmcnt(8)
  ds_read_b128 v[136:139], v6 offset:0
  ds_read_b128 v[140:143], v7 offset:0
  ds_read_b128 v[144:147], v8 offset:0
  ds_read_b128 v[148:151], v9 offset:0
  ds_read_b128 v[152:155], v10 offset:0
  ds_read_b128 v[156:159], v11 offset:0
  ds_read_b128 v[160:163], v12 offset:0
  ds_read_b128 v[164:167], v13 offset:0
  s_waitcnt lgkmcnt(7)
  v_mfma_f32_32x32x16_bf16 v[104:119], v[136:139], v[40:43], 0
  v_mfma_f32_32x32x16_bf16 v[120:135], v[136:139], v[72:75], 0
  s_waitcnt lgkmcnt(6)
  v_mfma_f32_32x32x16_bf16 v[104:119], v[140:143], v[44:47], v[104:119]
  v_mfma_f32_32x32x16_bf16 v[120:135], v[140:143], v[76:79], v[120:135]
  s_waitcnt lgkmcnt(5)
  v_mfma_f32_32x32x16_bf16 v[104:119], v[144:147], v[48:51], v[104:119]
  v_mfma_f32_32x32x16_bf16 v[120:135], v[144:147], v[80:83], v[120:135]
  s_waitcnt lgkmcnt(4)
  v_mfma_f32_32x32x16_bf16 v[104:119], v[148:151], v[52:55], v[104:119]
  v_mfma_f32_32x32x16_bf16 v[120:135], v[148:151], v[84:87], v[120:135]
  s_waitcnt lgkmcnt(3)
  v_mfma_f32_32x32x16_bf16 v[104:119], v[152:155], v[56:59], v[104:119]
  v_mfma_f32_32x32x16_bf16 v[120:135], v[152:155], v[88:91], v[120:135]
  s_waitcnt lgkmcnt(2)
  v_mfma_f32_32x32x16_bf16 v[104:119], v[156:159], v[60:63], v[104:119]
  v_mfma_f32_32x32x16_bf16 v[120:135], v[156:159], v[92:95], v[120:135]
  s_waitcnt lgkmcnt(1)
  v_mfma_f32_32x32x16_bf16 v[104:119], v[160:163], v[64:67], v[104:119]
  v_mfma_f32_32x32x16_bf16 v[120:135], v[160:163], v[96:99], v[120:135]
  s_waitcnt lgkmcnt(0)
  v_mfma_f32_32x32x16_bf16 v[104:119], v[164:167], v[68:71], v[104:119]
  v_mfma_f32_32x32x16_bf16 v[120:135], v[164:167], v[100:103], v[120:135]
  s_add_u32 m0, s47, 0
  s_add_u32 s50, s48, 0
  buffer_load_dwordx4 v2, s[24:27], s50 offen offset:0 nt lds
  buffer_load_dwordx4 v3, s[24:27], s50 offen offset:1024 nt lds
  buffer_load_dwordx4 v4, s[24:27], s50 offen offset:2048 nt lds
  buffer_load_dwordx4 v5, s[24:27], s50 offen offset:3072 nt lds
  s_add_u32 m0, s47, 4096
  s_add_u32 s50, s48, 8192
  buffer_load_dwordx4 v2, s[24:27], s50 offen offset:0 nt lds
  buffer_load_dwordx4 v3, s[24:27], s50 offen offset:1024 nt lds
  buffer_load_dwordx4 v4, s[24:27], s50 offen offset:2048 nt lds
  buffer_load_dwordx4 v5, s[24:27], s50 offen offset:3072 nt lds
  s_nop 1
  v_max3_f32 v30, v104, v105, v106
  v_max3_f32 v30, v30, v107, v108
  v_max3_f32 v30, v30, v109, v110
  v_max3_f32 v30, v30, v111, v112
  v_max3_f32 v30, v30, v113, v114
  v_max3_f32 v30, v30, v115, v116
  v_max3_f32 v30, v30, v117, v118
  v_max_f32 v30, v30, v119
  v_max3_f32 v31, v120, v121, v122
  v_max3_f32 v31, v31, v123, v124
  v_max3_f32 v31, v31, v125, v126
  v_max3_f32 v31, v31, v127, v128
  v_max3_f32 v31, v31, v129, v130
  v_max3_f32 v31, v31, v131, v132
  v_max3_f32 v31, v31, v133, v134
  v_max_f32 v31, v31, v135
  v_cmp_gt_f32 vcc, v30, v24
  v_cmp_gt_f32 s[64:65], v31, v25
  s_or_b64 s[64:65], s[64:65], vcc
  s_cbranch_scc0 L_k1_back1
  s_call_b64 s[68:69], L_k1_rare
L_k1_back1:
  v_fma_f32 v104, v104, s61, v38
  v_fma_f32 v105, v105, s61, v38
  v_fma_f32 v106, v106, s61, v38
  v_fma_f32 v107, v107, s61, v38
  v_fma_f32 v108, v108, s61, v38
  v_fma_f32 v109, v109, s61, v38
  v_fma_f32 v110, v110, s61, v38
  v_fma_f32 v111, v111, s61, v38
  v_fma_f32 v112, v112, s61, v38
  v_fma_f32 v113, v113, s61, v38
  v_fma_f32 v114, v114, s61, v38
  v_fma_f32 v115, v115, s61, v38
  v_fma_f32 v116, v116, s61, v38
  v_fma_f32 v117, v117, s61, v38
  v_fma_f32 v118, v118, s61, v38
  v_fma_f32 v119, v119, s61, v38
  v_exp_f32 v104, v104
  v_exp_f32 v105, v105
  v_exp_f32 v106, v106
  v_exp_f32 v107, v107
  v_exp_f32 v108, v108
  v_exp_f32 v109, v109
  v_exp_f32 v110, v110
  v_exp_f32 v111, v111
  v_exp_f32 v112, v112
  v_exp_f32 v113, v113
  v_exp_f32 v114, v114
  v_exp_f32 v115, v115
  v_exp_f32 v116, v116
  v_exp_f32 v117, v117
  v_exp_f32 v118, v118
  v_exp_f32 v119, v119
  v_fma_f32 v120, v120, s61, v39
  v_fma_f32 v121, v121, s61, v39
  v_fma_f32 v122, v122, s61, v39
  v_fma_f32 v123, v123, s61, v39
  v_fma_f32 v124, v124, s61, v39
  v_fma_f32 v125, v125, s61, v39
  v_fma_f32 v126, v126, s61, v39
  v_fma_f32 v127, v127, s61, v39
  v_fma_f32 v128, v128, s61, v39
  v_fma_f32 v129, v129, s61, v39
  v_fma_f32 v130, v130, s61, v39
  v_fma_f32 v131, v131, s61, v39
  v_fma_f32 v132, v132, s61, v39
  v_fma_f32 v133, v133, s61, v39
  v_fma_f32 v134, v134, s61, v39
  v_fma_f32 v135, v135, s61, v39
  v_exp_f32 v120, v120
  v_exp_f32 v121, v121
  v_exp_f32 v122, v122
  v_exp_f32 v123, v123
  v_exp_f32 v124, v124
  v_exp_f32 v125, v125
  v_exp_f32 v126, v126
  v_exp_f32 v127, v127
  v_exp_f32 v128, v128
  v_exp_f32 v129, v129
  v_exp_f32 v130, v130
  v_exp_f32 v131, v131
  v_exp_f32 v132, v132
  v_exp_f32 v133, v133
  v_exp_f32 v134, v134
  v_exp_f32 v135, v135
  v_add_f32 v26, v26, v104
  v_add_f32 v27, v27, v105
  v_add_f32 v26, v26, v106
  v_add_f32 v27, v27, v107
  v_add_f32 v26, v26, v108
  v_add_f32 v27, v27, v109
  v_add_f32 v26, v26, v110
  v_add_f32 v27, v27, v111
  v_add_f32 v26, v26, v112
  v_add_f32 v27, v27, v113
  v_add_f32 v26, v26, v114
  v_add_f32 v27, v27, v115
  v_add_f32 v26, v26, v116
  v_add_f32 v27, v27, v117
  v_add_f32 v26, v26, v118
  v_add_f32 v27, v27, v119
  v_cvt_pk_bf16_f32 v200, v104, v105
  v_cvt_pk_bf16_f32 v201, v106, v107
  v_cvt_pk_bf16_f32 v202, v108, v109
  v_cvt_pk_bf16_f32 v203, v110, v111
  v_cvt_pk_bf16_f32 v204, v112, v113
  v_cvt_pk_bf16_f32 v205, v114, v115
  v_cvt_pk_bf16_f32 v206, v116, v117
  v_cvt_pk_bf16_f32 v207, v118, v119
  v_add_f32 v28, v28, v120
  v_add_f32 v29, v29, v121
  v_add_f32 v28, v28, v122
  v_add_f32 v29, v29, v123
  v_add_f32 v28, v28, v124
  v_add_f32 v29, v29, v125
  v_add_f32 v28, v28, v126
  v_add_f32 v29, v29, v127
  v_add_f32 v28, v28, v128
  v_add_f32 v29, v29, v129
  v_add_f32 v28, v28, v130
  v_add_f32 v29, v29, v131
  v_add_f32 v28, v28, v132
  v_add_f32 v29, v29, v133
  v_add_f32 v28, v28, v134
  v_add_f32 v29, v29, v135
  v_cvt_pk_bf16_f32 v208, v120, v121
  v_cvt_pk_bf16_f32 v209, v122, v123
  v_cvt_pk_bf16_f32 v210, v124, v125
  v_cvt_pk_bf16_f32 v211, v126, v127
  v_cvt_pk_bf16_f32 v212, v128, v129
  v_cvt_pk_bf16_f32 v213, v130, v131
  v_cvt_pk_bf16_f32 v214, v132, v133
  v_cvt_pk_bf16_f32 v215, v134, v135
  s_waitcnt vmcnt(8)
  ds_read_b64_tr_b16 v[168:169], v14 offset:8192
  ds_read_b64_tr_b16 v[170:171], v15 offset:8192
  ds_read_b64_tr_b16 v[172:173], v14 offset:12288
  ds_read_b64_tr_b16 v[174:175], v15 offset:12288
  ds_read_b64_tr_b16 v[176:177], v16 offset:8192
  ds_read_b64_tr_b16 v[178:179], v17 offset:8192
  ds_read_b64_tr_b16 v[180:181], v16 offset:12288
  ds_read_b64_tr_b16 v[182:183], v17 offset:12288
  ds_read_b64_tr_b16 v[184:185], v18 offset:8192
  ds_read_b64_tr_b16 v[186:187], v19 offset:8192
  ds_read_b64_tr_b16 v[188:189], v18 offset:12288
  ds_read_b64_tr_b16 v[190:191], v19 offset:12288
  ds_read_b64_tr_b16 v[192:193], v20 offset:8192
  ds_read_b64_tr_b16 v[194:195], v21 offset:8192
  ds_read_b64_tr_b16 v[196:197], v20 offset:12288
  ds_read_b64_tr_b16 v[198:199], v21 offset:12288
  s_waitcnt lgkmcnt(14)
  v_mfma_f32_32x32x16_bf16 a[0:15], v[168:171], v[200:203], a[0:15]
  v_mfma_f32_32x32x16_bf16 a[16:31], v[168:171], v[208:211], a[16:31]
  s_waitcnt lgkmcnt(12)
  v_mfma_f32_32x32x16_bf16 a[0:15], v[172:175], v[204:207], a[0:15]
  v_mfma_f32_32x32x16_bf16 a[16:31], v[172:175], v[212:215], a[16:31]
  s_waitcnt lgkmcnt(10)
  v_mfma_f32_32x32x16_bf16 a[32:47], v[176:179], v[200:203], a[32:47]
  v_mfma_f32_32x32x16_bf16 a[48:63], v[176:179], v[208:211], a[48:63]
  s_waitcnt lgkmcnt(8)
  v_mfma_f32_32x32x16_bf16 a[32:47], v[180:183], v[204:207], a[32:47]
  v_mfma_f32_32x32x16_bf16 a[48:63], v[180:183], v[212:215], a[48:63]
  s_waitcnt lgkmcnt(6)
  v_mfma_f32_32x32x16_bf16 a[64:79], v[184:187], v[200:203], a[64:79]
  v_mfma_f32_32x32x16_bf16 a[80:95], v[184:187], v[208:211], a[80:95]
  s_waitcnt lgkmcnt(4)
  v_mfma_f32_32x32x16_bf16 a[64:79], v[188:191], v[204:207], a[64:79]
  v_mfma_f32_32x32x16_bf16 a[80:95], v[188:191], v[212:215], a[80:95]
  s_waitcnt lgkmcnt(2)
  v_mfma_f32_32x32x16_bf16 a[96:111], v[192:195], v[200:203], a[96:111]
  v_mfma_f32_32x32x16_bf16 a[112:127], v[192:195], v[208:211], a[112:127]
  s_waitcnt lgkmcnt(0)
  v_mfma_f32_32x32x16_bf16 a[96:111], v[196:199], v[204:207], a[96:111]
  v_mfma_f32_32x32x16_bf16 a[112:127], v[196:199], v[212:215], a[112:127]
  s_add_u32 m0, s47, 8192
  s_add_u32 s50, s48, 0
  buffer_load_dwordx4 v2, s[28:31], s50 offen offset:0 nt lds
  buffer_load_dwordx4 v3, s[28:31], s50 offen offset:1024 nt lds
  buffer_load_dwordx4 v4, s[28:31], s50 offen offset:2048 nt lds
  buffer_load_dwordx4 v5, s[28:31], s50 offen offset:3072 nt lds
  s_add_u32 m0, s47, 12288
  s_add_u32 s50, s48, 8192
  buffer_load_dwordx4 v2, s[28:31], s50 offen offset:0 nt lds
  buffer_load_dwordx4 v3, s[28:31], s50 offen offset:1024 nt lds
  buffer_load_dwordx4 v4, s[28:31], s50 offen offset:2048 nt lds
  buffer_load_dwordx4 v5, s[28:31], s50 offen offset:3072 nt lds
  s_add_u32 s48, s48, 16384
  s_add_u32 s58, s58, 1
  s_cmp_lt_u32 s58, 14
  s_cbranch_scc1 L_k1_loop
  s_waitcnt vmcnt(8)
  ds_read_b128 v[136:139], v6 offset:0
  ds_read_b128 v[140:143], v7 offset:0
  ds_read_b128 v[144:147], v8 offset:0
  ds_read_b128 v[148:151], v9 offset:0
  ds_read_b128 v[152:155], v10 offset:0
  ds_read_b128 v[156:159], v11 offset:0
  ds_read_b128 v[160:163], v12 offset:0
  ds_read_b128 v[164:167], v13 offset:0
  s_waitcnt lgkmcnt(7)
  v_mfma_f32_32x32x16_bf16 v[104:119], v[136:139], v[40:43], 0
  v_mfma_f32_32x32x16_bf16 v[120:135], v[136:139], v[72:75], 0
  s_waitcnt lgkmcnt(6)
  v_mfma_f32_32x32x16_bf16 v[104:119], v[140:143], v[44:47], v[104:119]
  v_mfma_f32_32x32x16_bf16 v[120:135], v[140:143], v[76:79], v[120:135]
  s_waitcnt lgkmcnt(5)
  v_mfma_f32_32x32x16_bf16 v[104:119], v[144:147], v[48:51], v[104:119]
  v_mfma_f32_32x32x16_bf16 v[120:135], v[144:147], v[80:83], v[120:135]
  s_waitcnt lgkmcnt(4)
  v_mfma_f32_32x32x16_bf16 v[104:119], v[148:151], v[52:55], v[104:119]
  v_mfma_f32_32x32x16_bf16 v[120:135], v[148:151], v[84:87], v[120:135]
  s_waitcnt lgkmcnt(3)
  v_mfma_f32_32x32x16_bf16 v[104:119], v[152:155], v[56:59], v[104:119]
  v_mfma_f32_32x32x16_bf16 v[120:135], v[152:155], v[88:91], v[120:135]
  s_waitcnt lgkmcnt(2)
  v_mfma_f32_32x32x16_bf16 v[104:119], v[156:159], v[60:63], v[104:119]
  v_mfma_f32_32x32x16_bf16 v[120:135], v[156:159], v[92:95], v[120:135]
  s_waitcnt lgkmcnt(1)
  v_mfma_f32_32x32x16_bf16 v[104:119], v[160:163], v[64:67], v[104:119]
  v_mfma_f32_32x32x16_bf16 v[120:135], v[160:163], v[96:99], v[120:135]
  s_waitcnt lgkmcnt(0)
  v_mfma_f32_32x32x16_bf16 v[104:119], v[164:167], v[68:71], v[104:119]
  v_mfma_f32_32x32x16_bf16 v[120:135], v[164:167], v[100:103], v[120:135]
  s_add_u32 m0, s47, 0
  s_add_u32 s50, s48, 0
  buffer_load_dwordx4 v2, s[24:27], s50 offen offset:0 nt lds
  buffer_load_dwordx4 v3, s[24:27], s50 offen offset:1024 nt lds
  buffer_load_dwordx4 v4, s[24:27], s50 offen offset:2048 nt lds
  buffer_load_dwordx4 v5, s[24:27], s50 offen offset:3072 nt lds
  s_add_u32 m0, s47, 4096
  s_add_u32 s50, s48, 8192
  buffer_load_dwordx4 v2, s[24:27], s50 offen offset:0 nt lds
  buffer_load_dwordx4 v3, s[24:27], s50 offen offset:1024 nt lds
  buffer_load_dwordx4 v4, s[24:27], s50 offen offset:2048 nt lds
  buffer_load_dwordx4 v5, s[24:27], s50 offen offset:3072 nt lds
  s_nop 1
  v_max3_f32 v30, v104, v105, v106
  v_max3_f32 v30, v30, v107, v108
  v_max3_f32 v30, v30, v109, v110
  v_max3_f32 v30, v30, v111, v112
  v_max3_f32 v30, v30, v113, v114
  v_max3_f32 v30, v30, v115, v116
  v_max3_f32 v30, v30, v117, v118
  v_max_f32 v30, v30, v119
  v_max3_f32 v31, v120, v121, v122
  v_max3_f32 v31, v31, v123, v124
  v_max3_f32 v31, v31, v125, v126
  v_max3_f32 v31, v31, v127, v128
  v_max3_f32 v31, v31, v129, v130
  v_max3_f32 v31, v31, v131, v132
  v_max3_f32 v31, v31, v133, v134
  v_max_f32 v31, v31, v135
  v_cmp_gt_f32 vcc, v30, v24
  v_cmp_gt_f32 s[64:65], v31, v25
  s_or_b64 s[64:65], s[64:65], vcc
  s_cbranch_scc0 L_k1_back3
  s_call_b64 s[68:69], L_k1_rare
L_k1_back3:
  v_fma_f32 v104, v104, s61, v38
  v_fma_f32 v105, v105, s61, v38
  v_fma_f32 v106, v106, s61, v38
  v_fma_f32 v107, v107, s61, v38
  v_fma_f32 v108, v108, s61, v38
  v_fma_f32 v109, v109, s61, v38
  v_fma_f32 v110, v110, s61, v38
  v_fma_f32 v111, v111, s61, v38
  v_fma_f32 v112, v112, s61, v38
  v_fma_f32 v113, v113, s61, v38
  v_fma_f32 v114, v114, s61, v38
  v_fma_f32 v115, v115, s61, v38
  v_fma_f32 v116, v116, s61, v38
  v_fma_f32 v117, v117, s61, v38
  v_fma_f32 v118, v118, s61, v38
  v_fma_f32 v119, v119, s61, v38
  v_exp_f32 v104, v104
  v_exp_f32 v105, v105
  v_exp_f32 v106, v106
  v_exp_f32 v107, v107
  v_exp_f32 v108, v108
  v_exp_f32 v109, v109
  v_exp_f32 v110, v110
  v_exp_f32 v111, v111
  v_exp_f32 v112, v112
  v_exp_f32 v113, v113
  v_exp_f32 v114, v114
  v_exp_f32 v115, v115
  v_exp_f32 v116, v116
  v_exp_f32 v117, v117
  v_exp_f32 v118, v118
  v_exp_f32 v119, v119
  v_fma_f32 v120, v120, s61, v39
  v_fma_f32 v121, v121, s61, v39
  v_fma_f32 v122, v122, s61, v39
  v_fma_f32 v123, v123, s61, v39
  v_fma_f32 v124, v124, s61, v39
  v_fma_f32 v125, v125, s61, v39
  v_fma_f32 v126, v126, s61, v39
  v_fma_f32 v127, v127, s61, v39
  v_fma_f32 v128, v128, s61, v39
  v_fma_f32 v129, v129, s61, v39
  v_fma_f32 v130, v130, s61, v39
  v_fma_f32 v131, v131, s61, v39
  v_fma_f32 v132, v132, s61, v39
  v_fma_f32 v133, v133, s61, v39
  v_fma_f32 v134, v134, s61, v39
  v_fma_f32 v135, v135, s61, v39
  v_exp_f32 v120, v120
  v_exp_f32 v121, v121
  v_exp_f32 v122, v122
  v_exp_f32 v123, v123
  v_exp_f32 v124, v124
  v_exp_f32 v125, v125
  v_exp_f32 v126, v126
  v_exp_f32 v127, v127
  v_exp_f32 v128, v128
  v_exp_f32 v129, v129
  v_exp_f32 v130, v130
  v_exp_f32 v131, v131
  v_exp_f32 v132, v132
  v_exp_f32 v133, v133
  v_exp_f32 v134, v134
  v_exp_f32 v135, v135
  v_add_f32 v26, v26, v104
  v_add_f32 v27, v27, v105
  v_add_f32 v26, v26, v106
  v_add_f32 v27, v27, v107
  v_add_f32 v26, v26, v108
  v_add_f32 v27, v27, v109
  v_add_f32 v26, v26, v110
  v_add_f32 v27, v27, v111
  v_add_f32 v26, v26, v112
  v_add_f32 v27, v27, v113
  v_add_f32 v26, v26, v114
  v_add_f32 v27, v27, v115
  v_add_f32 v26, v26, v116
  v_add_f32 v27, v27, v117
  v_add_f32 v26, v26, v118
  v_add_f32 v27, v27, v119
  v_cvt_pk_bf16_f32 v200, v104, v105
  v_cvt_pk_bf16_f32 v201, v106, v107
  v_cvt_pk_bf16_f32 v202, v108, v109
  v_cvt_pk_bf16_f32 v203, v110, v111
  v_cvt_pk_bf16_f32 v204, v112, v113
  v_cvt_pk_bf16_f32 v205, v114, v115
  v_cvt_pk_bf16_f32 v206, v116, v117
  v_cvt_pk_bf16_f32 v207, v118, v119
  v_add_f32 v28, v28, v120
  v_add_f32 v29, v29, v121
  v_add_f32 v28, v28, v122
  v_add_f32 v29, v29, v123
  v_add_f32 v28, v28, v124
  v_add_f32 v29, v29, v125
  v_add_f32 v28, v28, v126
  v_add_f32 v29, v29, v127
  v_add_f32 v28, v28, v128
  v_add_f32 v29, v29, v129
  v_add_f32 v28, v28, v130
  v_add_f32 v29, v29, v131
  v_add_f32 v28, v28, v132
  v_add_f32 v29, v29, v133
  v_add_f32 v28, v28, v134
  v_add_f32 v29, v29, v135
  v_cvt_pk_bf16_f32 v208, v120, v121
  v_cvt_pk_bf16_f32 v209, v122, v123
  v_cvt_pk_bf16_f32 v210, v124, v125
  v_cvt_pk_bf16_f32 v211, v126, v127
  v_cvt_pk_bf16_f32 v212, v128, v129
  v_cvt_pk_bf16_f32 v213, v130, v131
  v_cvt_pk_bf16_f32 v214, v132, v133
  v_cvt_pk_bf16_f32 v215, v134, v135
  v_mov_b32 v217, 0
  global_load_dword v216, v217, s[22:23] sc1
  s_waitcnt vmcnt(9)
  ds_read_b64_tr_b16 v[168:169], v14 offset:8192
  ds_read_b64_tr_b16 v[170:171], v15 offset:8192
  ds_read_b64_tr_b16 v[172:173], v14 offset:12288
  ds_read_b64_tr_b16 v[174:175], v15 offset:12288
  ds_read_b64_tr_b16 v[176:177], v16 offset:8192
  ds_read_b64_tr_b16 v[178:179], v17 offset:8192
  ds_read_b64_tr_b16 v[180:181], v16 offset:12288
  ds_read_b64_tr_b16 v[182:183], v17 offset:12288
  ds_read_b64_tr_b16 v[184:185], v18 offset:8192
  ds_read_b64_tr_b16 v[186:187], v19 offset:8192
  ds_read_b64_tr_b16 v[188:189], v18 offset:12288
  ds_read_b64_tr_b16 v[190:191], v19 offset:12288
  ds_read_b64_tr_b16 v[192:193], v20 offset:8192
  ds_read_b64_tr_b16 v[194:195], v21 offset:8192
  ds_read_b64_tr_b16 v[196:197], v20 offset:12288
  ds_read_b64_tr_b16 v[198:199], v21 offset:12288
  s_waitcnt lgkmcnt(14)
  v_mfma_f32_32x32x16_bf16 a[0:15], v[168:171], v[200:203], a[0:15]
  v_mfma_f32_32x32x16_bf16 a[16:31], v[168:171], v[208:211], a[16:31]
  s_waitcnt lgkmcnt(12)
  v_mfma_f32_32x32x16_bf16 a[0:15], v[172:175], v[204:207], a[0:15]
  v_mfma_f32_32x32x16_bf16 a[16:31], v[172:175], v[212:215], a[16:31]
  s_waitcnt lgkmcnt(10)
  v_mfma_f32_32x32x16_bf16 a[32:47], v[176:179], v[200:203], a[32:47]
  v_mfma_f32_32x32x16_bf16 a[48:63], v[176:179], v[208:211], a[48:63]
  s_waitcnt lgkmcnt(8)
  v_mfma_f32_32x32x16_bf16 a[32:47], v[180:183], v[204:207], a[32:47]
  v_mfma_f32_32x32x16_bf16 a[48:63], v[180:183], v[212:215], a[48:63]
  s_waitcnt lgkmcnt(6)
  v_mfma_f32_32x32x16_bf16 a[64:79], v[184:187], v[200:203], a[64:79]
  v_mfma_f32_32x32x16_bf16 a[80:95], v[184:187], v[208:211], a[80:95]
  s_waitcnt lgkmcnt(4)
  v_mfma_f32_32x32x16_bf16 a[64:79], v[188:191], v[204:207], a[64:79]
  v_mfma_f32_32x32x16_bf16 a[80:95], v[188:191], v[212:215], a[80:95]
  s_waitcnt lgkmcnt(2)
  v_mfma_f32_32x32x16_bf16 a[96:111], v[192:195], v[200:203], a[96:111]
  v_mfma_f32_32x32x16_bf16 a[112:127], v[192:195], v[208:211], a[112:127]
  s_waitcnt lgkmcnt(0)
  v_mfma_f32_32x32x16_bf16 a[96:111], v[196:199], v[204:207], a[96:111]
  v_mfma_f32_32x32x16_bf16 a[112:127], v[196:199], v[212:215], a[112:127]
  s_add_u32 m0, s47, 8192
  s_add_u32 s50, s48, 0
  buffer_load_dwordx4 v2, s[28:31], s50 offen offset:0 nt lds
  buffer_load_dwordx4 v3, s[28:31], s50 offen offset:1024 nt lds
  buffer_load_dwordx4 v4, s[28:31], s50 offen offset:2048 nt lds
  buffer_load_dwordx4 v5, s[28:31], s50 offen offset:3072 nt lds
  s_add_u32 m0, s47, 12288
  s_add_u32 s50, s48, 8192
  buffer_load_dwordx4 v2, s[28:31], s50 offen offset:0 nt lds
  buffer_load_dwordx4 v3, s[28:31], s50 offen offset:1024 nt lds
  buffer_load_dwordx4 v4, s[28:31], s50 offen offset:2048 nt lds
  buffer_load_dwordx4 v5, s[28:31], s50 offen offset:3072 nt lds
  s_add_u32 s48, s48, 16384
  s_waitcnt vmcnt(9)
  ds_read_b128 v[136:139], v6 offset:0
  ds_read_b128 v[140:143], v7 offset:0
  ds_read_b128 v[144:147], v8 offset:0
  ds_read_b128 v[148:151], v9 offset:0
  ds_read_b128 v[152:155], v10 offset:0
  ds_read_b128 v[156:159], v11 offset:0
  ds_read_b128 v[160:163], v12 offset:0
  ds_read_b128 v[164:167], v13 offset:0
  s_waitcnt lgkmcnt(7)
  v_mfma_f32_32x32x16_bf16 v[104:119], v[136:139], v[40:43], 0
  v_mfma_f32_32x32x16_bf16 v[120:135], v[136:139], v[72:75], 0
  s_waitcnt lgkmcnt(6)
  v_mfma_f32_32x32x16_bf16 v[104:119], v[140:143], v[44:47], v[104:119]
  v_mfma_f32_32x32x16_bf16 v[120:135], v[140:143], v[76:79], v[120:135]
  s_waitcnt lgkmcnt(5)
  v_mfma_f32_32x32x16_bf16 v[104:119], v[144:147], v[48:51], v[104:119]
  v_mfma_f32_32x32x16_bf16 v[120:135], v[144:147], v[80:83], v[120:135]
  s_waitcnt lgkmcnt(4)
  v_mfma_f32_32x32x16_bf16 v[104:119], v[148:151], v[52:55], v[104:119]
  v_mfma_f32_32x32x16_bf16 v[120:135], v[148:151], v[84:87], v[120:135]
  s_waitcnt lgkmcnt(3)
  v_mfma_f32_32x32x16_bf16 v[104:119], v[152:155], v[56:59], v[104:119]
  v_mfma_f32_32x32x16_bf16 v[120:135], v[152:155], v[88:91], v[120:135]
  s_waitcnt lgkmcnt(2)
  v_mfma_f32_32x32x16_bf16 v[104:119], v[156:159], v[60:63], v[104:119]
  v_mfma_f32_32x32x16_bf16 v[120:135], v[156:159], v[92:95], v[120:135]
  s_waitcnt lgkmcnt(1)
  v_mfma_f32_32x32x16_bf16 v[104:119], v[160:163], v[64:67], v[104:119]
  v_mfma_f32_32x32x16_bf16 v[120:135], v[160:163], v[96:99], v[120:135]
  s_waitcnt lgkmcnt(0)
  v_mfma_f32_32x32x16_bf16 v[104:119], v[164:167], v[68:71], v[104:119]
  v_mfma_f32_32x32x16_bf16 v[120:135], v[164:167], v[100:103], v[120:135]
  s_nop 7
  s_nop 5
  v_max3_f32 v30, v104, v105, v106
  v_max3_f32 v30, v30, v107, v108
  v_max3_f32 v30, v30, v109, v110
  v_max3_f32 v30, v30, v111, v112
  v_max3_f32 v30, v30, v113, v114
  v_max3_f32 v30, v30, v115, v116
  v_max3_f32 v30, v30, v117, v118
  v_max_f32 v30, v30, v119
  v_max3_f32 v31, v120, v121, v122
  v_max3_f32 v31, v31, v123, v124
  v_max3_f32 v31, v31, v125, v126
  v_max3_f32 v31, v31, v127, v128
  v_max3_f32 v31, v31, v129, v130
  v_max3_f32 v31, v31, v131, v132
  v_max3_f32 v31, v31, v133, v134
  v_max_f32 v31, v31, v135
  v_cmp_gt_f32 vcc, v30, v24
  v_cmp_gt_f32 s[64:65], v31, v25
  s_or_b64 s[64:65], s[64:65], vcc
  s_cbranch_scc0 L_k1_back4
  s_call_b64 s[68:69], L_k1_rare
L_k1_back4:
  v_fma_f32 v104, v104, s61, v38
  v_fma_f32 v105, v105, s61, v38
  v_fma_f32 v106, v106, s61, v38
  v_fma_f32 v107, v107, s61, v38
  v_fma_f32 v108, v108, s61, v38
  v_fma_f32 v109, v109, s61, v38
  v_fma_f32 v110, v110, s61, v38
  v_fma_f32 v111, v111, s61, v38
  v_fma_f32 v112, v112, s61, v38
  v_fma_f32 v113, v113, s61, v38
  v_fma_f32 v114, v114, s61, v38
  v_fma_f32 v115, v115, s61, v38
  v_fma_f32 v116, v116, s61, v38
  v_fma_f32 v117, v117, s61, v38
  v_fma_f32 v118, v118, s61, v38
  v_fma_f32 v119, v119, s61, v38
  v_exp_f32 v104, v104
  v_exp_f32 v105, v105
  v_exp_f32 v106, v106
  v_exp_f32 v107, v107
  v_exp_f32 v108, v108
  v_exp_f32 v109, v109
  v_exp_f32 v110, v110
  v_exp_f32 v111, v111
  v_exp_f32 v112, v112
  v_exp_f32 v113, v113
  v_exp_f32 v114, v114
  v_exp_f32 v115, v115
  v_exp_f32 v116, v116
  v_exp_f32 v117, v117
  v_exp_f32 v118, v118
  v_exp_f32 v119, v119
  v_fma_f32 v120, v120, s61, v39
  v_fma_f32 v121, v121, s61, v39
  v_fma_f32 v122, v122, s61, v39
  v_fma_f32 v123, v123, s61, v39
  v_fma_f32 v124, v124, s61, v39
  v_fma_f32 v125, v125, s61, v39
  v_fma_f32 v126, v126, s61, v39
  v_fma_f32 v127, v127, s61, v39
  v_fma_f32 v128, v128, s61, v39
  v_fma_f32 v129, v129, s61, v39
  v_fma_f32 v130, v130, s61, v39
  v_fma_f32 v131, v131, s61, v39
  v_fma_f32 v132, v132, s61, v39
  v_fma_f32 v133, v133, s61, v39
  v_fma_f32 v134, v134, s61, v39
  v_fma_f32 v135, v135, s61, v39
  v_exp_f32 v120, v120
  v_exp_f32 v121, v121
  v_exp_f32 v122, v122
  v_exp_f32 v123, v123
  v_exp_f32 v124, v124
  v_exp_f32 v125, v125
  v_exp_f32 v126, v126
  v_exp_f32 v127, v127
  v_exp_f32 v128, v128
  v_exp_f32 v129, v129
  v_exp_f32 v130, v130
  v_exp_f32 v131, v131
  v_exp_f32 v132, v132
  v_exp_f32 v133, v133
  v_exp_f32 v134, v134
  v_exp_f32 v135, v135
  v_add_f32 v26, v26, v104
  v_add_f32 v27, v27, v105
  v_add_f32 v26, v26, v106
  v_add_f32 v27, v27, v107
  v_add_f32 v26, v26, v108
  v_add_f32 v27, v27, v109
  v_add_f32 v26, v26, v110
  v_add_f32 v27, v27, v111
  v_add_f32 v26, v26, v112
  v_add_f32 v27, v27, v113
  v_add_f32 v26, v26, v114
  v_add_f32 v27, v27, v115
  v_add_f32 v26, v26, v116
  v_add_f32 v27, v27, v117
  v_add_f32 v26, v26, v118
  v_add_f32 v27, v27, v119
  v_cvt_pk_bf16_f32 v200, v104, v105
  v_cvt_pk_bf16_f32 v201, v106, v107
  v_cvt_pk_bf16_f32 v202, v108, v109
  v_cvt_pk_bf16_f32 v203, v110, v111
  v_cvt_pk_bf16_f32 v204, v112, v113
  v_cvt_pk_bf16_f32 v205, v114, v115
  v_cvt_pk_bf16_f32 v206, v116, v117
  v_cvt_pk_bf16_f32 v207, v118, v119
  v_add_f32 v28, v28, v120
  v_add_f32 v29, v29, v121
  v_add_f32 v28, v28, v122
  v_add_f32 v29, v29, v123
  v_add_f32 v28, v28, v124
  v_add_f32 v29, v29, v125
  v_add_f32 v28, v28, v126
  v_add_f32 v29, v29, v127
  v_add_f32 v28, v28, v128
  v_add_f32 v29, v29, v129
  v_add_f32 v28, v28, v130
  v_add_f32 v29, v29, v131
  v_add_f32 v28, v28, v132
  v_add_f32 v29, v29, v133
  v_add_f32 v28, v28, v134
  v_add_f32 v29, v29, v135
  v_cvt_pk_bf16_f32 v208, v120, v121
  v_cvt_pk_bf16_f32 v209, v122, v123
  v_cvt_pk_bf16_f32 v210, v124, v125
  v_cvt_pk_bf16_f32 v211, v126, v127
  v_cvt_pk_bf16_f32 v212, v128, v129
  v_cvt_pk_bf16_f32 v213, v130, v131
  v_cvt_pk_bf16_f32 v214, v132, v133
  v_cvt_pk_bf16_f32 v215, v134, v135
  s_waitcnt vmcnt(0)
  ds_read_b64_tr_b16 v[168:169], v14 offset:8192
  ds_read_b64_tr_b16 v[170:171], v15 offset:8192
  ds_read_b64_tr_b16 v[172:173], v14 offset:12288
  ds_read_b64_tr_b16 v[174:175], v15 offset:12288
  ds_read_b64_tr_b16 v[176:177], v16 offset:8192
  ds_read_b64_tr_b16 v[178:179], v17 offset:8192
  ds_read_b64_tr_b16 v[180:181], v16 offset:12288
  ds_read_b64_tr_b16 v[182:183], v17 offset:12288
  ds_read_b64_tr_b16 v[184:185], v18 offset:8192
  ds_read_b64_tr_b16 v[186:187], v19 offset:8192
  ds_read_b64_tr_b16 v[188:189], v18 offset:12288
  ds_read_b64_tr_b16 v[190:191], v19 offset:12288
  ds_read_b64_tr_b16 v[192:193], v20 offset:8192
  ds_read_b64_tr_b16 v[194:195], v21 offset:8192
  ds_read_b64_tr_b16 v[196:197], v20 offset:12288
  ds_read_b64_tr_b16 v[198:199], v21 offset:12288
  s_waitcnt lgkmcnt(14)
  v_mfma_f32_32x32x16_bf16 a[0:15], v[168:171], v[200:203], a[0:15]
  v_mfma_f32_32x32x16_bf16 a[16:31], v[168:171], v[208:211], a[16:31]
  s_waitcnt lgkmcnt(12)
  v_mfma_f32_32x32x16_bf16 a[0:15], v[172:175], v[204:207], a[0:15]
  v_mfma_f32_32x32x16_bf16 a[16:31], v[172:175], v[212:215], a[16:31]
  s_waitcnt lgkmcnt(10)
  v_mfma_f32_32x32x16_bf16 a[32:47], v[176:179], v[200:203], a[32:47]
  v_mfma_f32_32x32x16_bf16 a[48:63], v[176:179], v[208:211], a[48:63]
  s_waitcnt lgkmcnt(8)
  v_mfma_f32_32x32x16_bf16 a[32:47], v[180:183], v[204:207], a[32:47]
  v_mfma_f32_32x32x16_bf16 a[48:63], v[180:183], v[212:215], a[48:63]
  s_waitcnt lgkmcnt(6)
  v_mfma_f32_32x32x16_bf16 a[64:79], v[184:187], v[200:203], a[64:79]
  v_mfma_f32_32x32x16_bf16 a[80:95], v[184:187], v[208:211], a[80:95]
  s_waitcnt lgkmcnt(4)
  v_mfma_f32_32x32x16_bf16 a[64:79], v[188:191], v[204:207], a[64:79]
  v_mfma_f32_32x32x16_bf16 a[80:95], v[188:191], v[212:215], a[80:95]
  s_waitcnt lgkmcnt(2)
  v_mfma_f32_32x32x16_bf16 a[96:111], v[192:195], v[200:203], a[96:111]
  v_mfma_f32_32x32x16_bf16 a[112:127], v[192:195], v[208:211], a[112:127]
  s_waitcnt lgkmcnt(0)
  v_mfma_f32_32x32x16_bf16 a[96:111], v[196:199], v[204:207], a[96:111]
  v_mfma_f32_32x32x16_bf16 a[112:127], v[196:199], v[212:215], a[112:127]
  s_branch L_k1_epi
L_k1_rare:
  v_mov_b32 v32, v30
  v_mov_b32 v33, v31
  s_nop 1
  v_permlane32_swap_b32 v30, v32
  v_permlane32_swap_b32 v31, v33
  s_nop 1
  v_max3_f32 v30, v30, v32, v22
  v_max3_f32 v31, v31, v33, v23
  v_sub_f32 v32, v22, v30
  v_sub_f32 v33, v23, v31
  v_mul_f32 v32, s61, v32
  v_mul_f32 v33, s61, v33
  v_exp_f32 v32, v32
  v_exp_f32 v33, v33
  v_mov_b32 v22, v30
  v_add_f32 v24, 0x427af233, v30
  v_mul_f32 v38, 0xbe0293ee, v30
  v_mov_b32 v23, v31
  v_add_f32 v25, 0x427af233, v31
  v_mul_f32 v39, 0xbe0293ee, v31
  v_mul_f32 v26, v26, v32
  v_mul_f32 v27, v27, v32
  v_mul_f32 v28, v28, v33
  v_mul_f32 v29, v29, v33
  v_accvgpr_read_b32 v34, a0
  v_accvgpr_read_b32 v35, a1
  v_accvgpr_read_b32 v36, a2
  v_accvgpr_read_b32 v37, a3
  v_mul_f32 v34, v34, v32
  v_mul_f32 v35, v35, v32
  v_mul_f32 v36, v36, v32
  v_mul_f32 v37, v37, v32
  v_accvgpr_write_b32 a0, v34
  v_accvgpr_write_b32 a1, v35
  v_accvgpr_write_b32 a2, v36
  v_accvgpr_write_b32 a3, v37
  v_accvgpr_read_b32 v34, a4
  v_accvgpr_read_b32 v35, a5
  v_accvgpr_read_b32 v36, a6
  v_accvgpr_read_b32 v37, a7
  v_mul_f32 v34, v34, v32
  v_mul_f32 v35, v35, v32
  v_mul_f32 v36, v36, v32
  v_mul_f32 v37, v37, v32
  v_accvgpr_write_b32 a4, v34
  v_accvgpr_write_b32 a5, v35
  v_accvgpr_write_b32 a6, v36
  v_accvgpr_write_b32 a7, v37
  v_accvgpr_read_b32 v34, a8
  v_accvgpr_read_b32 v35, a9
  v_accvgpr_read_b32 v36, a10
  v_accvgpr_read_b32 v37, a11
  v_mul_f32 v34, v34, v32
  v_mul_f32 v35, v35, v32
  v_mul_f32 v36, v36, v32
  v_mul_f32 v37, v37, v32
  v_accvgpr_write_b32 a8, v34
  v_accvgpr_write_b32 a9, v35
  v_accvgpr_write_b32 a10, v36
  v_accvgpr_write_b32 a11, v37
  v_accvgpr_read_b32 v34, a12
  v_accvgpr_read_b32 v35, a13
  v_accvgpr_read_b32 v36, a14
  v_accvgpr_read_b32 v37, a15
  v_mul_f32 v34, v34, v32
  v_mul_f32 v35, v35, v32
  v_mul_f32 v36, v36, v32
  v_mul_f32 v37, v37, v32
  v_accvgpr_write_b32 a12, v34
  v_accvgpr_write_b32 a13, v35
  v_accvgpr_write_b32 a14, v36
  v_accvgpr_write_b32 a15, v37
  v_accvgpr_read_b32 v34, a16
  v_accvgpr_read_b32 v35, a17
  v_accvgpr_read_b32 v36, a18
  v_accvgpr_read_b32 v37, a19
  v_mul_f32 v34, v34, v33
  v_mul_f32 v35, v35, v33
  v_mul_f32 v36, v36, v33
  v_mul_f32 v37, v37, v33
  v_accvgpr_write_b32 a16, v34
  v_accvgpr_write_b32 a17, v35
  v_accvgpr_write_b32 a18, v36
  v_accvgpr_write_b32 a19, v37
  v_accvgpr_read_b32 v34, a20
  v_accvgpr_read_b32 v35, a21
  v_accvgpr_read_b32 v36, a22
  v_accvgpr_read_b32 v37, a23
  v_mul_f32 v34, v34, v33
  v_mul_f32 v35, v35, v33
  v_mul_f32 v36, v36, v33
  v_mul_f32 v37, v37, v33
  v_accvgpr_write_b32 a20, v34
  v_accvgpr_write_b32 a21, v35
  v_accvgpr_write_b32 a22, v36
  v_accvgpr_write_b32 a23, v37
  v_accvgpr_read_b32 v34, a24
  v_accvgpr_read_b32 v35, a25
  v_accvgpr_read_b32 v36, a26
  v_accvgpr_read_b32 v37, a27
  v_mul_f32 v34, v34, v33
  v_mul_f32 v35, v35, v33
  v_mul_f32 v36, v36, v33
  v_mul_f32 v37, v37, v33
  v_accvgpr_write_b32 a24, v34
  v_accvgpr_write_b32 a25, v35
  v_accvgpr_write_b32 a26, v36
  v_accvgpr_write_b32 a27, v37
  v_accvgpr_read_b32 v34, a28
  v_accvgpr_read_b32 v35, a29
  v_accvgpr_read_b32 v36, a30
  v_accvgpr_read_b32 v37, a31
  v_mul_f32 v34, v34, v33
  v_mul_f32 v35, v35, v33
  v_mul_f32 v36, v36, v33
  v_mul_f32 v37, v37, v33
  v_accvgpr_write_b32 a28, v34
  v_accvgpr_write_b32 a29, v35
  v_accvgpr_write_b32 a30, v36
  v_accvgpr_write_b32 a31, v37
  v_accvgpr_read_b32 v34, a32
  v_accvgpr_read_b32 v35, a33
  v_accvgpr_read_b32 v36, a34
  v_accvgpr_read_b32 v37, a35
  v_mul_f32 v34, v34, v32
  v_mul_f32 v35, v35, v32
  v_mul_f32 v36, v36, v32
  v_mul_f32 v37, v37, v32
  v_accvgpr_write_b32 a32, v34
  v_accvgpr_write_b32 a33, v35
  v_accvgpr_write_b32 a34, v36
  v_accvgpr_write_b32 a35, v37
  v_accvgpr_read_b32 v34, a36
  v_accvgpr_read_b32 v35, a37
  v_accvgpr_read_b32 v36, a38
  v_accvgpr_read_b32 v37, a39
  v_mul_f32 v34, v34, v32
  v_mul_f32 v35, v35, v32
  v_mul_f32 v36, v36, v32
  v_mul_f32 v37, v37, v32
  v_accvgpr_write_b32 a36, v34
  v_accvgpr_write_b32 a37, v35
  v_accvgpr_write_b32 a38, v36
  v_accvgpr_write_b32 a39, v37
  v_accvgpr_read_b32 v34, a40
  v_accvgpr_read_b32 v35, a41
  v_accvgpr_read_b32 v36, a42
  v_accvgpr_read_b32 v37, a43
  v_mul_f32 v34, v34, v32
  v_mul_f32 v35, v35, v32
  v_mul_f32 v36, v36, v32
  v_mul_f32 v37, v37, v32
  v_accvgpr_write_b32 a40, v34
  v_accvgpr_write_b32 a41, v35
  v_accvgpr_write_b32 a42, v36
  v_accvgpr_write_b32 a43, v37
  v_accvgpr_read_b32 v34, a44
  v_accvgpr_read_b32 v35, a45
  v_accvgpr_read_b32 v36, a46
  v_accvgpr_read_b32 v37, a47
  v_mul_f32 v34, v34, v32
  v_mul_f32 v35, v35, v32
  v_mul_f32 v36, v36, v32
  v_mul_f32 v37, v37, v32
  v_accvgpr_write_b32 a44, v34
  v_accvgpr_write_b32 a45, v35
  v_accvgpr_write_b32 a46, v36
  v_accvgpr_write_b32 a47, v37
  v_accvgpr_read_b32 v34, a48
  v_accvgpr_read_b32 v35, a49
  v_accvgpr_read_b32 v36, a50
  v_accvgpr_read_b32 v37, a51
  v_mul_f32 v34, v34, v33
  v_mul_f32 v35, v35, v33
  v_mul_f32 v36, v36, v33
  v_mul_f32 v37, v37, v33
  v_accvgpr_write_b32 a48, v34
  v_accvgpr_write_b32 a49, v35
  v_accvgpr_write_b32 a50, v36
  v_accvgpr_write_b32 a51, v37
  v_accvgpr_read_b32 v34, a52
  v_accvgpr_read_b32 v35, a53
  v_accvgpr_read_b32 v36, a54
  v_accvgpr_read_b32 v37, a55
  v_mul_f32 v34, v34, v33
  v_mul_f32 v35, v35, v33
  v_mul_f32 v36, v36, v33
  v_mul_f32 v37, v37, v33
  v_accvgpr_write_b32 a52, v34
  v_accvgpr_write_b32 a53, v35
  v_accvgpr_write_b32 a54, v36
  v_accvgpr_write_b32 a55, v37
  v_accvgpr_read_b32 v34, a56
  v_accvgpr_read_b32 v35, a57
  v_accvgpr_read_b32 v36, a58
  v_accvgpr_read_b32 v37, a59
  v_mul_f32 v34, v34, v33
  v_mul_f32 v35, v35, v33
  v_mul_f32 v36, v36, v33
  v_mul_f32 v37, v37, v33
  v_accvgpr_write_b32 a56, v34
  v_accvgpr_write_b32 a57, v35
  v_accvgpr_write_b32 a58, v36
  v_accvgpr_write_b32 a59, v37
  v_accvgpr_read_b32 v34, a60
  v_accvgpr_read_b32 v35, a61
  v_accvgpr_read_b32 v36, a62
  v_accvgpr_read_b32 v37, a63
  v_mul_f32 v34, v34, v33
  v_mul_f32 v35, v35, v33
  v_mul_f32 v36, v36, v33
  v_mul_f32 v37, v37, v33
  v_accvgpr_write_b32 a60, v34
  v_accvgpr_write_b32 a61, v35
  v_accvgpr_write_b32 a62, v36
  v_accvgpr_write_b32 a63, v37
  v_accvgpr_read_b32 v34, a64
  v_accvgpr_read_b32 v35, a65
  v_accvgpr_read_b32 v36, a66
  v_accvgpr_read_b32 v37, a67
  v_mul_f32 v34, v34, v32
  v_mul_f32 v35, v35, v32
  v_mul_f32 v36, v36, v32
  v_mul_f32 v37, v37, v32
  v_accvgpr_write_b32 a64, v34
  v_accvgpr_write_b32 a65, v35
  v_accvgpr_write_b32 a66, v36
  v_accvgpr_write_b32 a67, v37
  v_accvgpr_read_b32 v34, a68
  v_accvgpr_read_b32 v35, a69
  v_accvgpr_read_b32 v36, a70
  v_accvgpr_read_b32 v37, a71
  v_mul_f32 v34, v34, v32
  v_mul_f32 v35, v35, v32
  v_mul_f32 v36, v36, v32
  v_mul_f32 v37, v37, v32
  v_accvgpr_write_b32 a68, v34
  v_accvgpr_write_b32 a69, v35
  v_accvgpr_write_b32 a70, v36
  v_accvgpr_write_b32 a71, v37
  v_accvgpr_read_b32 v34, a72
  v_accvgpr_read_b32 v35, a73
  v_accvgpr_read_b32 v36, a74
  v_accvgpr_read_b32 v37, a75
  v_mul_f32 v34, v34, v32
  v_mul_f32 v35, v35, v32
  v_mul_f32 v36, v36, v32
  v_mul_f32 v37, v37, v32
  v_accvgpr_write_b32 a72, v34
  v_accvgpr_write_b32 a73, v35
  v_accvgpr_write_b32 a74, v36
  v_accvgpr_write_b32 a75, v37
  v_accvgpr_read_b32 v34, a76
  v_accvgpr_read_b32 v35, a77
  v_accvgpr_read_b32 v36, a78
  v_accvgpr_read_b32 v37, a79
  v_mul_f32 v34, v34, v32
  v_mul_f32 v35, v35, v32
  v_mul_f32 v36, v36, v32
  v_mul_f32 v37, v37, v32
  v_accvgpr_write_b32 a76, v34
  v_accvgpr_write_b32 a77, v35
  v_accvgpr_write_b32 a78, v36
  v_accvgpr_write_b32 a79, v37
  v_accvgpr_read_b32 v34, a80
  v_accvgpr_read_b32 v35, a81
  v_accvgpr_read_b32 v36, a82
  v_accvgpr_read_b32 v37, a83
  v_mul_f32 v34, v34, v33
  v_mul_f32 v35, v35, v33
  v_mul_f32 v36, v36, v33
  v_mul_f32 v37, v37, v33
  v_accvgpr_write_b32 a80, v34
  v_accvgpr_write_b32 a81, v35
  v_accvgpr_write_b32 a82, v36
  v_accvgpr_write_b32 a83, v37
  v_accvgpr_read_b32 v34, a84
  v_accvgpr_read_b32 v35, a85
  v_accvgpr_read_b32 v36, a86
  v_accvgpr_read_b32 v37, a87
  v_mul_f32 v34, v34, v33
  v_mul_f32 v35, v35, v33
  v_mul_f32 v36, v36, v33
  v_mul_f32 v37, v37, v33
  v_accvgpr_write_b32 a84, v34
  v_accvgpr_write_b32 a85, v35
  v_accvgpr_write_b32 a86, v36
  v_accvgpr_write_b32 a87, v37
  v_accvgpr_read_b32 v34, a88
  v_accvgpr_read_b32 v35, a89
  v_accvgpr_read_b32 v36, a90
  v_accvgpr_read_b32 v37, a91
  v_mul_f32 v34, v34, v33
  v_mul_f32 v35, v35, v33
  v_mul_f32 v36, v36, v33
  v_mul_f32 v37, v37, v33
  v_accvgpr_write_b32 a88, v34
  v_accvgpr_write_b32 a89, v35
  v_accvgpr_write_b32 a90, v36
  v_accvgpr_write_b32 a91, v37
  v_accvgpr_read_b32 v34, a92
  v_accvgpr_read_b32 v35, a93
  v_accvgpr_read_b32 v36, a94
  v_accvgpr_read_b32 v37, a95
  v_mul_f32 v34, v34, v33
  v_mul_f32 v35, v35, v33
  v_mul_f32 v36, v36, v33
  v_mul_f32 v37, v37, v33
  v_accvgpr_write_b32 a92, v34
  v_accvgpr_write_b32 a93, v35
  v_accvgpr_write_b32 a94, v36
  v_accvgpr_write_b32 a95, v37
  v_accvgpr_read_b32 v34, a96
  v_accvgpr_read_b32 v35, a97
  v_accvgpr_read_b32 v36, a98
  v_accvgpr_read_b32 v37, a99
  v_mul_f32 v34, v34, v32
  v_mul_f32 v35, v35, v32
  v_mul_f32 v36, v36, v32
  v_mul_f32 v37, v37, v32
  v_accvgpr_write_b32 a96, v34
  v_accvgpr_write_b32 a97, v35
  v_accvgpr_write_b32 a98, v36
  v_accvgpr_write_b32 a99, v37
  v_accvgpr_read_b32 v34, a100
  v_accvgpr_read_b32 v35, a101
  v_accvgpr_read_b32 v36, a102
  v_accvgpr_read_b32 v37, a103
  v_mul_f32 v34, v34, v32
  v_mul_f32 v35, v35, v32
  v_mul_f32 v36, v36, v32
  v_mul_f32 v37, v37, v32
  v_accvgpr_write_b32 a100, v34
  v_accvgpr_write_b32 a101, v35
  v_accvgpr_write_b32 a102, v36
  v_accvgpr_write_b32 a103, v37
  v_accvgpr_read_b32 v34, a104
  v_accvgpr_read_b32 v35, a105
  v_accvgpr_read_b32 v36, a106
  v_accvgpr_read_b32 v37, a107
  v_mul_f32 v34, v34, v32
  v_mul_f32 v35, v35, v32
  v_mul_f32 v36, v36, v32
  v_mul_f32 v37, v37, v32
  v_accvgpr_write_b32 a104, v34
  v_accvgpr_write_b32 a105, v35
  v_accvgpr_write_b32 a106, v36
  v_accvgpr_write_b32 a107, v37
  v_accvgpr_read_b32 v34, a108
  v_accvgpr_read_b32 v35, a109
  v_accvgpr_read_b32 v36, a110
  v_accvgpr_read_b32 v37, a111
  v_mul_f32 v34, v34, v32
  v_mul_f32 v35, v35, v32
  v_mul_f32 v36, v36, v32
  v_mul_f32 v37, v37, v32
  v_accvgpr_write_b32 a108, v34
  v_accvgpr_write_b32 a109, v35
  v_accvgpr_write_b32 a110, v36
  v_accvgpr_write_b32 a111, v37
  v_accvgpr_read_b32 v34, a112
  v_accvgpr_read_b32 v35, a113
  v_accvgpr_read_b32 v36, a114
  v_accvgpr_read_b32 v37, a115
  v_mul_f32 v34, v34, v33
  v_mul_f32 v35, v35, v33
  v_mul_f32 v36, v36, v33
  v_mul_f32 v37, v37, v33
  v_accvgpr_write_b32 a112, v34
  v_accvgpr_write_b32 a113, v35
  v_accvgpr_write_b32 a114, v36
  v_accvgpr_write_b32 a115, v37
  v_accvgpr_read_b32 v34, a116
  v_accvgpr_read_b32 v35, a117
  v_accvgpr_read_b32 v36, a118
  v_accvgpr_read_b32 v37, a119
  v_mul_f32 v34, v34, v33
  v_mul_f32 v35, v35, v33
  v_mul_f32 v36, v36, v33
  v_mul_f32 v37, v37, v33
  v_accvgpr_write_b32 a116, v34
  v_accvgpr_write_b32 a117, v35
  v_accvgpr_write_b32 a118, v36
  v_accvgpr_write_b32 a119, v37
  v_accvgpr_read_b32 v34, a120
  v_accvgpr_read_b32 v35, a121
  v_accvgpr_read_b32 v36, a122
  v_accvgpr_read_b32 v37, a123
  v_mul_f32 v34, v34, v33
  v_mul_f32 v35, v35, v33
  v_mul_f32 v36, v36, v33
  v_mul_f32 v37, v37, v33
  v_accvgpr_write_b32 a120, v34
  v_accvgpr_write_b32 a121, v35
  v_accvgpr_write_b32 a122, v36
  v_accvgpr_write_b32 a123, v37
  v_accvgpr_read_b32 v34, a124
  v_accvgpr_read_b32 v35, a125
  v_accvgpr_read_b32 v36, a126
  v_accvgpr_read_b32 v37, a127
  v_mul_f32 v34, v34, v33
  v_mul_f32 v35, v35, v33
  v_mul_f32 v36, v36, v33
  v_mul_f32 v37, v37, v33
  v_accvgpr_write_b32 a124, v34
  v_accvgpr_write_b32 a125, v35
  v_accvgpr_write_b32 a126, v36
  v_accvgpr_write_b32 a127, v37
  s_nop 1
  s_setpc_b64 s[68:69]
L_k1_epi:
  s_waitcnt vmcnt(0)
  s_mov_b32 s52, 131072
L_k1_nonce_poll:
  v_readfirstlane_b32 s62, v216
  s_cmp_lg_u32 s62, 0
  s_cbranch_scc1 L_k1_nonce_ok
  global_load_dword v216, v217, s[22:23] sc1
  s_waitcnt vmcnt(0)
  s_sub_u32 s52, s52, 1
  s_cmp_lg_u32 s52, 0
  s_cbranch_scc1 L_k1_nonce_poll
L_k1_nonce_ok:
  v_add_f32 v26, v26, v27
  v_mov_b32 v27, v26
  v_add_f32 v28, v28, v29
  v_mov_b32 v29, v28
  s_nop 1
  v_permlane32_swap_b32 v26, v27
  v_permlane32_swap_b32 v28, v29
  s_nop 1
  v_add_f32 v32, v26, v27
  v_mov_b32 v30, v22
  v_add_f32 v33, v28, v29
  v_mov_b32 v31, v23
  v_lshlrev_b32 v6, 4, v1
  s_xor_b32 s50, s47, 65536
  v_add_u32 v7, s50, v6
  v_add_u32 v6, s47, v6
  ds_write_b128 v6, v[30:33] offset:16384
  v_bfe_u32 v8, v1, 4, 1
  v_lshlrev_b32 v8, 10, v8
  v_lshrrev_b32 v9, 5, v1
  v_lshlrev_b32 v9, 8, v9
  v_add_u32 v8, v8, v9
  v_and_b32 v9, 15, v1
  v_lshlrev_b32 v9, 4, v9
  v_add_u32 v8, v8, v9
  s_cmp_eq_u32 s46, 0
  s_cbranch_scc0 L_k1_epi1
  ds_write_b128 v6, a[64:67] offset:0
  ds_write_b128 v6, a[68:71] offset:1024
  ds_write_b128 v6, a[72:75] offset:2048
  ds_write_b128 v6, a[76:79] offset:3072
  ds_write_b128 v6, a[80:83] offset:4096
  ds_write_b128 v6, a[84:87] offset:5120
  ds_write_b128 v6, a[88:91] offset:6144
  ds_write_b128 v6, a[92:95] offset:7168
  ds_write_b128 v6, a[96:99] offset:8192
  ds_write_b128 v6, a[100:103] offset:9216
  ds_write_b128 v6, a[104:107] offset:10240
  ds_write_b128 v6, a[108:111] offset:11264
  ds_write_b128 v6, a[112:115] offset:12288
  ds_write_b128 v6, a[116:119] offset:13312
  ds_write_b128 v6, a[120:123] offset:14336
  ds_write_b128 v6, a[124:127] offset:15360
  v_accvgpr_read_b32 v40, a0
  v_accvgpr_read_b32 v41, a1
  v_accvgpr_read_b32 v42, a2
  v_accvgpr_read_b32 v43, a3
  v_accvgpr_read_b32 v44, a4
  v_accvgpr_read_b32 v45, a5
  v_accvgpr_read_b32 v46, a6
  v_accvgpr_read_b32 v47, a7
  v_accvgpr_read_b32 v48, a8
  v_accvgpr_read_b32 v49, a9
  v_accvgpr_read_b32 v50, a10
  v_accvgpr_read_b32 v51, a11
  v_accvgpr_read_b32 v52, a12
  v_accvgpr_read_b32 v53, a13
  v_accvgpr_read_b32 v54, a14
  v_accvgpr_read_b32 v55, a15
  v_accvgpr_read_b32 v56, a16
  v_accvgpr_read_b32 v57, a17
  v_accvgpr_read_b32 v58, a18
  v_accvgpr_read_b32 v59, a19
  v_accvgpr_read_b32 v60, a20
  v_accvgpr_read_b32 v61, a21
  v_accvgpr_read_b32 v62, a22
  v_accvgpr_read_b32 v63, a23
  v_accvgpr_read_b32 v64, a24
  v_accvgpr_read_b32 v65, a25
  v_accvgpr_read_b32 v66, a26
  v_accvgpr_read_b32 v67, a27
  v_accvgpr_read_b32 v68, a28
  v_accvgpr_read_b32 v69, a29
  v_accvgpr_read_b32 v70, a30
  v_accvgpr_read_b32 v71, a31
  v_accvgpr_read_b32 v72, a32
  v_accvgpr_read_b32 v73, a33
  v_accvgpr_read_b32 v74, a34
  v_accvgpr_read_b32 v75, a35
  v_accvgpr_read_b32 v76, a36
  v_accvgpr_read_b32 v77, a37
  v_accvgpr_read_b32 v78, a38
  v_accvgpr_read_b32 v79, a39
  v_accvgpr_read_b32 v80, a40
  v_accvgpr_read_b32 v81, a41
  v_accvgpr_read_b32 v82, a42
  v_accvgpr_read_b32 v83, a43
  v_accvgpr_read_b32 v84, a44
  v_accvgpr_read_b32 v85, a45
  v_accvgpr_read_b32 v86, a46
  v_accvgpr_read_b32 v87, a47
  v_accvgpr_read_b32 v88, a48
  v_accvgpr_read_b32 v89, a49
  v_accvgpr_read_b32 v90, a50
  v_accvgpr_read_b32 v91, a51
  v_accvgpr_read_b32 v92, a52
  v_accvgpr_read_b32 v93, a53
  v_accvgpr_read_b32 v94, a54
  v_accvgpr_read_b32 v95, a55
  v_accvgpr_read_b32 v96, a56
  v_accvgpr_read_b32 v97, a57
  v_accvgpr_read_b32 v98, a58
  v_accvgpr_read_b32 v99, a59
  v_accvgpr_read_b32 v100, a60
  v_accvgpr_read_b32 v101, a61
  v_accvgpr_read_b32 v102, a62
  v_accvgpr_read_b32 v103, a63
  s_waitcnt lgkmcnt(0)
  s_barrier
  ds_read_b128 v[34:37], v7 offset:16384
  ds_read_b128 v[104:107], v7 offset:0
  ds_read_b128 v[108:111], v7 offset:1024
  ds_read_b128 v[112:115], v7 offset:2048
  ds_read_b128 v[116:119], v7 offset:3072
  ds_read_b128 v[120:123], v7 offset:4096
  ds_read_b128 v[124:127], v7 offset:5120
  ds_read_b128 v[128:131], v7 offset:6144
  ds_read_b128 v[132:135], v7 offset:7168
  ds_read_b128 v[136:139], v7 offset:8192
  ds_read_b128 v[140:143], v7 offset:9216
  ds_read_b128 v[144:147], v7 offset:10240
  ds_read_b128 v[148:151], v7 offset:11264
  ds_read_b128 v[152:155], v7 offset:12288
  ds_read_b128 v[156:159], v7 offset:13312
  ds_read_b128 v[160:163], v7 offset:14336
  ds_read_b128 v[164:167], v7 offset:15360
  s_waitcnt lgkmcnt(15)
  v_max_f32 v204, v30, v34
  v_max_f32 v205, v31, v35
  v_sub_f32 v200, v30, v204
  v_sub_f32 v202, v34, v204
  v_sub_f32 v201, v31, v205
  v_sub_f32 v203, v35, v205
  v_mul_f32 v200, s61, v200
  v_mul_f32 v202, s61, v202
  v_mul_f32 v201, s61, v201
  v_mul_f32 v203, s61, v203
  v_exp_f32 v200, v200
  v_exp_f32 v202, v202
  v_exp_f32 v201, v201
  v_exp_f32 v203, v203
  s_nop 0
  v_mul_f32 v204, v32, v200
  v_fma_f32 v204, v36, v202, v204
  v_mul_f32 v205, v33, v201
  v_fma_f32 v205, v37, v203, v205
  v_rcp_f32 v204, v204
  v_rcp_f32 v205, v205
  s_nop 0
  v_mul_f32 v208, v200, v204
  v_mul_f32 v209, v202, v204
  v_mul_f32 v210, v201, v205
  v_mul_f32 v211, v203, v205
  s_mov_b32 s50, 0
  s_waitcnt lgkmcnt(12)
  v_mul_f32 v104, v104, v209
  v_mul_f32 v105, v105, v209
  v_mul_f32 v106, v106, v209
  v_mul_f32 v107, v107, v209
  v_mul_f32 v108, v108, v209
  v_mul_f32 v109, v109, v209
  v_mul_f32 v110, v110, v209
  v_mul_f32 v111, v111, v209
  v_mul_f32 v112, v112, v209
  v_mul_f32 v113, v113, v209
  v_mul_f32 v114, v114, v209
  v_mul_f32 v115, v115, v209
  v_mul_f32 v116, v116, v209
  v_mul_f32 v117, v117, v209
  v_mul_f32 v118, v118, v209
  v_mul_f32 v119, v119, v209
  v_fmac_f32 v104, v40, v208
  v_fmac_f32 v105, v41, v208
  v_fmac_f32 v106, v42, v208
  v_fmac_f32 v107, v43, v208
  v_fmac_f32 v108, v44, v208
  v_fmac_f32 v109, v45, v208
  v_fmac_f32 v110, v46, v208
  v_fmac_f32 v111, v47, v208
  v_fmac_f32 v112, v48, v208
  v_fmac_f32 v113, v49, v208
  v_fmac_f32 v114, v50, v208
  v_fmac_f32 v115, v51, v208
  v_fmac_f32 v116, v52, v208
  v_fmac_f32 v117, v53, v208
  v_fmac_f32 v118, v54, v208
  v_fmac_f32 v119, v55, v208
  v_cvt_pk_bf16_f32 v168, v104, v105
  v_cvt_pk_bf16_f32 v169, v106, v107
  v_cvt_pk_bf16_f32 v170, v108, v109
  v_cvt_pk_bf16_f32 v171, v110, v111
  buffer_store_dwordx4 v[168:171], v8, s[40:43], s50 offen offset:0 sc1
  v_cvt_pk_bf16_f32 v172, v112, v113
  v_cvt_pk_bf16_f32 v173, v114, v115
  v_cvt_pk_bf16_f32 v174, v116, v117
  v_cvt_pk_bf16_f32 v175, v118, v119
  buffer_store_dwordx4 v[172:175], v8, s[40:43], s50 offen offset:512 sc1
  s_waitcnt lgkmcnt(8)
  v_mul_f32 v120, v120, v211
  v_mul_f32 v121, v121, v211
  v_mul_f32 v122, v122, v211
  v_mul_f32 v123, v123, v211
  v_mul_f32 v124, v124, v211
  v_mul_f32 v125, v125, v211
  v_mul_f32 v126, v126, v211
  v_mul_f32 v127, v127, v211
  v_mul_f32 v128, v128, v211
  v_mul_f32 v129, v129, v211
  v_mul_f32 v130, v130, v211
  v_mul_f32 v131, v131, v211
  v_mul_f32 v132, v132, v211
  v_mul_f32 v133, v133, v211
  v_mul_f32 v134, v134, v211
  v_mul_f32 v135, v135, v211
  v_fmac_f32 v120, v56, v210
  v_fmac_f32 v121, v57, v210
  v_fmac_f32 v122, v58, v210
  v_fmac_f32 v123, v59, v210
  v_fmac_f32 v124, v60, v210
  v_fmac_f32 v125, v61, v210
  v_fmac_f32 v126, v62, v210
  v_fmac_f32 v127, v63, v210
  v_fmac_f32 v128, v64, v210
  v_fmac_f32 v129, v65, v210
  v_fmac_f32 v130, v66, v210
  v_fmac_f32 v131, v67, v210
  v_fmac_f32 v132, v68, v210
  v_fmac_f32 v133, v69, v210
  v_fmac_f32 v134, v70, v210
  v_fmac_f32 v135, v71, v210
  v_cvt_pk_bf16_f32 v176, v120, v121
  v_cvt_pk_bf16_f32 v177, v122, v123
  v_cvt_pk_bf16_f32 v178, v124, v125
  v_cvt_pk_bf16_f32 v179, v126, v127
  buffer_store_dwordx4 v[176:179], v8, s[40:43], s50 offen offset:2048 sc1
  v_cvt_pk_bf16_f32 v180, v128, v129
  v_cvt_pk_bf16_f32 v181, v130, v131
  v_cvt_pk_bf16_f32 v182, v132, v133
  v_cvt_pk_bf16_f32 v183, v134, v135
  buffer_store_dwordx4 v[180:183], v8, s[40:43], s50 offen offset:2560 sc1
  s_mov_b32 s50, 4096
  s_waitcnt lgkmcnt(4)
  v_mul_f32 v136, v136, v209
  v_mul_f32 v137, v137, v209
  v_mul_f32 v138, v138, v209
  v_mul_f32 v139, v139, v209
  v_mul_f32 v140, v140, v209
  v_mul_f32 v141, v141, v209
  v_mul_f32 v142, v142, v209
  v_mul_f32 v143, v143, v209
  v_mul_f32 v144, v144, v209
  v_mul_f32 v145, v145, v209
  v_mul_f32 v146, v146, v209
  v_mul_f32 v147, v147, v209
  v_mul_f32 v148, v148, v209
  v_mul_f32 v149, v149, v209
  v_mul_f32 v150, v150, v209
  v_mul_f32 v151, v151, v209
  v_fmac_f32 v136, v72, v208
  v_fmac_f32 v137, v73, v208
  v_fmac_f32 v138, v74, v208
  v_fmac_f32 v139, v75, v208
  v_fmac_f32 v140, v76, v208
  v_fmac_f32 v141, v77, v208
  v_fmac_f32 v142, v78, v208
  v_fmac_f32 v143, v79, v208
  v_fmac_f32 v144, v80, v208
  v_fmac_f32 v145, v81, v208
  v_fmac_f32 v146, v82, v208
  v_fmac_f32 v147, v83, v208
  v_fmac_f32 v148, v84, v208
  v_fmac_f32 v149, v85, v208
  v_fmac_f32 v150, v86, v208
  v_fmac_f32 v151, v87, v208
  v_cvt_pk_bf16_f32 v184, v136, v137
  v_cvt_pk_bf16_f32 v185, v138, v139
  v_cvt_pk_bf16_f32 v186, v140, v141
  v_cvt_pk_bf16_f32 v187, v142, v143
  buffer_store_dwordx4 v[184:187], v8, s[40:43], s50 offen offset:0 sc1
  v_cvt_pk_bf16_f32 v188, v144, v145
  v_cvt_pk_bf16_f32 v189, v146, v147
  v_cvt_pk_bf16_f32 v190, v148, v149
  v_cvt_pk_bf16_f32 v191, v150, v151
  buffer_store_dwordx4 v[188:191], v8, s[40:43], s50 offen offset:512 sc1
  s_waitcnt lgkmcnt(0)
  v_mul_f32 v152, v152, v211
  v_mul_f32 v153, v153, v211
  v_mul_f32 v154, v154, v211
  v_mul_f32 v155, v155, v211
  v_mul_f32 v156, v156, v211
  v_mul_f32 v157, v157, v211
  v_mul_f32 v158, v158, v211
  v_mul_f32 v159, v159, v211
  v_mul_f32 v160, v160, v211
  v_mul_f32 v161, v161, v211
  v_mul_f32 v162, v162, v211
  v_mul_f32 v163, v163, v211
  v_mul_f32 v164, v164, v211
  v_mul_f32 v165, v165, v211
  v_mul_f32 v166, v166, v211
  v_mul_f32 v167, v167, v211
  v_fmac_f32 v152, v88, v210
  v_fmac_f32 v153, v89, v210
  v_fmac_f32 v154, v90, v210
  v_fmac_f32 v155, v91, v210
  v_fmac_f32 v156, v92, v210
  v_fmac_f32 v157, v93, v210
  v_fmac_f32 v158, v94, v210
  v_fmac_f32 v159, v95, v210
  v_fmac_f32 v160, v96, v210
  v_fmac_f32 v161, v97, v210
  v_fmac_f32 v162, v98, v210
  v_fmac_f32 v163, v99, v210
  v_fmac_f32 v164, v100, v210
  v_fmac_f32 v165, v101, v210
  v_fmac_f32 v166, v102, v210
  v_fmac_f32 v167, v103, v210
  v_cvt_pk_bf16_f32 v192, v152, v153
  v_cvt_pk_bf16_f32 v193, v154, v155
  v_cvt_pk_bf16_f32 v194, v156, v157
  v_cvt_pk_bf16_f32 v195, v158, v159
  buffer_store_dwordx4 v[192:195], v8, s[40:43], s50 offen offset:2048 sc1
  v_cvt_pk_bf16_f32 v196, v160, v161
  v_cvt_pk_bf16_f32 v197, v162, v163
  v_cvt_pk_bf16_f32 v198, v164, v165
  v_cvt_pk_bf16_f32 v199, v166, v167
  buffer_store_dwordx4 v[196:199], v8, s[40:43], s50 offen offset:2560 sc1
  s_branch L_k1_fin
L_k1_epi1:
  ds_write_b128 v6, a[0:3] offset:0
  ds_write_b128 v6, a[4:7] offset:1024
  ds_write_b128 v6, a[8:11] offset:2048
  ds_write_b128 v6, a[12:15] offset:3072
  ds_write_b128 v6, a[16:19] offset:4096
  ds_write_b128 v6, a[20:23] offset:5120
  ds_write_b128 v6, a[24:27] offset:6144
  ds_write_b128 v6, a[28:31] offset:7168
  ds_write_b128 v6, a[32:35] offset:8192
  ds_write_b128 v6, a[36:39] offset:9216
  ds_write_b128 v6, a[40:43] offset:10240
  ds_write_b128 v6, a[44:47] offset:11264
  ds_write_b128 v6, a[48:51] offset:12288
  ds_write_b128 v6, a[52:55] offset:13312
  ds_write_b128 v6, a[56:59] offset:14336
  ds_write_b128 v6, a[60:63] offset:15360
  v_accvgpr_read_b32 v40, a64
  v_accvgpr_read_b32 v41, a65
  v_accvgpr_read_b32 v42, a66
  v_accvgpr_read_b32 v43, a67
  v_accvgpr_read_b32 v44, a68
  v_accvgpr_read_b32 v45, a69
  v_accvgpr_read_b32 v46, a70
  v_accvgpr_read_b32 v47, a71
  v_accvgpr_read_b32 v48, a72
  v_accvgpr_read_b32 v49, a73
  v_accvgpr_read_b32 v50, a74
  v_accvgpr_read_b32 v51, a75
  v_accvgpr_read_b32 v52, a76
  v_accvgpr_read_b32 v53, a77
  v_accvgpr_read_b32 v54, a78
  v_accvgpr_read_b32 v55, a79
  v_accvgpr_read_b32 v56, a80
  v_accvgpr_read_b32 v57, a81
  v_accvgpr_read_b32 v58, a82
  v_accvgpr_read_b32 v59, a83
  v_accvgpr_read_b32 v60, a84
  v_accvgpr_read_b32 v61, a85
  v_accvgpr_read_b32 v62, a86
  v_accvgpr_read_b32 v63, a87
  v_accvgpr_read_b32 v64, a88
  v_accvgpr_read_b32 v65, a89
  v_accvgpr_read_b32 v66, a90
  v_accvgpr_read_b32 v67, a91
  v_accvgpr_read_b32 v68, a92
  v_accvgpr_read_b32 v69, a93
  v_accvgpr_read_b32 v70, a94
  v_accvgpr_read_b32 v71, a95
  v_accvgpr_read_b32 v72, a96
  v_accvgpr_read_b32 v73, a97
  v_accvgpr_read_b32 v74, a98
  v_accvgpr_read_b32 v75, a99
  v_accvgpr_read_b32 v76, a100
  v_accvgpr_read_b32 v77, a101
  v_accvgpr_read_b32 v78, a102
  v_accvgpr_read_b32 v79, a103
  v_accvgpr_read_b32 v80, a104
  v_accvgpr_read_b32 v81, a105
  v_accvgpr_read_b32 v82, a106
  v_accvgpr_read_b32 v83, a107
  v_accvgpr_read_b32 v84, a108
  v_accvgpr_read_b32 v85, a109
  v_accvgpr_read_b32 v86, a110
  v_accvgpr_read_b32 v87, a111
  v_accvgpr_read_b32 v88, a112
  v_accvgpr_read_b32 v89, a113
  v_accvgpr_read_b32 v90, a114
  v_accvgpr_read_b32 v91, a115
  v_accvgpr_read_b32 v92, a116
  v_accvgpr_read_b32 v93, a117
  v_accvgpr_read_b32 v94, a118
  v_accvgpr_read_b32 v95, a119
  v_accvgpr_read_b32 v96, a120
  v_accvgpr_read_b32 v97, a121
  v_accvgpr_read_b32 v98, a122
  v_accvgpr_read_b32 v99, a123
  v_accvgpr_read_b32 v100, a124
  v_accvgpr_read_b32 v101, a125
  v_accvgpr_read_b32 v102, a126
  v_accvgpr_read_b32 v103, a127
  s_waitcnt lgkmcnt(0)
  s_barrier
  ds_read_b128 v[34:37], v7 offset:16384
  ds_read_b128 v[104:107], v7 offset:0
  ds_read_b128 v[108:111], v7 offset:1024
  ds_read_b128 v[112:115], v7 offset:2048
  ds_read_b128 v[116:119], v7 offset:3072
  ds_read_b128 v[120:123], v7 offset:4096
  ds_read_b128 v[124:127], v7 offset:5120
  ds_read_b128 v[128:131], v7 offset:6144
  ds_read_b128 v[132:135], v7 offset:7168
  ds_read_b128 v[136:139], v7 offset:8192
  ds_read_b128 v[140:143], v7 offset:9216
  ds_read_b128 v[144:147], v7 offset:10240
  ds_read_b128 v[148:151], v7 offset:11264
  ds_read_b128 v[152:155], v7 offset:12288
  ds_read_b128 v[156:159], v7 offset:13312
  ds_read_b128 v[160:163], v7 offset:14336
  ds_read_b128 v[164:167], v7 offset:15360
  s_waitcnt lgkmcnt(15)
  v_max_f32 v204, v30, v34
  v_max_f32 v205, v31, v35
  v_sub_f32 v200, v30, v204
  v_sub_f32 v202, v34, v204
  v_sub_f32 v201, v31, v205
  v_sub_f32 v203, v35, v205
  v_mul_f32 v200, s61, v200
  v_mul_f32 v202, s61, v202
  v_mul_f32 v201, s61, v201
  v_mul_f32 v203, s61, v203
  v_exp_f32 v200, v200
  v_exp_f32 v202, v202
  v_exp_f32 v201, v201
  v_exp_f32 v203, v203
  s_nop 0
  v_mul_f32 v204, v32, v200
  v_fma_f32 v204, v36, v202, v204
  v_mul_f32 v205, v33, v201
  v_fma_f32 v205, v37, v203, v205
  v_rcp_f32 v204, v204
  v_rcp_f32 v205, v205
  s_nop 0
  v_mul_f32 v208, v200, v204
  v_mul_f32 v209, v202, v204
  v_mul_f32 v210, v201, v205
  v_mul_f32 v211, v203, v205
  s_mov_b32 s50, 8192
  s_waitcnt lgkmcnt(12)
  v_mul_f32 v104, v104, v209
  v_mul_f32 v105, v105, v209
  v_mul_f32 v106, v106, v209
  v_mul_f32 v107, v107, v209
  v_mul_f32 v108, v108, v209
  v_mul_f32 v109, v109, v209
  v_mul_f32 v110, v110, v209
  v_mul_f32 v111, v111, v209
  v_mul_f32 v112, v112, v209
  v_mul_f32 v113, v113, v209
  v_mul_f32 v114, v114, v209
  v_mul_f32 v115, v115, v209
  v_mul_f32 v116, v116, v209
  v_mul_f32 v117, v117, v209
  v_mul_f32 v118, v118, v209
  v_mul_f32 v119, v119, v209
  v_fmac_f32 v104, v40, v208
  v_fmac_f32 v105, v41, v208
  v_fmac_f32 v106, v42, v208
  v_fmac_f32 v107, v43, v208
  v_fmac_f32 v108, v44, v208
  v_fmac_f32 v109, v45, v208
  v_fmac_f32 v110, v46, v208
  v_fmac_f32 v111, v47, v208
  v_fmac_f32 v112, v48, v208
  v_fmac_f32 v113, v49, v208
  v_fmac_f32 v114, v50, v208
  v_fmac_f32 v115, v51, v208
  v_fmac_f32 v116, v52, v208
  v_fmac_f32 v117, v53, v208
  v_fmac_f32 v118, v54, v208
  v_fmac_f32 v119, v55, v208
  v_cvt_pk_bf16_f32 v168, v104, v105
  v_cvt_pk_bf16_f32 v169, v106, v107
  v_cvt_pk_bf16_f32 v170, v108, v109
  v_cvt_pk_bf16_f32 v171, v110, v111
  buffer_store_dwordx4 v[168:171], v8, s[40:43], s50 offen offset:0 sc1
  v_cvt_pk_bf16_f32 v172, v112, v113
  v_cvt_pk_bf16_f32 v173, v114, v115
  v_cvt_pk_bf16_f32 v174, v116, v117
  v_cvt_pk_bf16_f32 v175, v118, v119
  buffer_store_dwordx4 v[172:175], v8, s[40:43], s50 offen offset:512 sc1
  s_waitcnt lgkmcnt(8)
  v_mul_f32 v120, v120, v211
  v_mul_f32 v121, v121, v211
  v_mul_f32 v122, v122, v211
  v_mul_f32 v123, v123, v211
  v_mul_f32 v124, v124, v211
  v_mul_f32 v125, v125, v211
  v_mul_f32 v126, v126, v211
  v_mul_f32 v127, v127, v211
  v_mul_f32 v128, v128, v211
  v_mul_f32 v129, v129, v211
  v_mul_f32 v130, v130, v211
  v_mul_f32 v131, v131, v211
  v_mul_f32 v132, v132, v211
  v_mul_f32 v133, v133, v211
  v_mul_f32 v134, v134, v211
  v_mul_f32 v135, v135, v211
  v_fmac_f32 v120, v56, v210
  v_fmac_f32 v121, v57, v210
  v_fmac_f32 v122, v58, v210
  v_fmac_f32 v123, v59, v210
  v_fmac_f32 v124, v60, v210
  v_fmac_f32 v125, v61, v210
  v_fmac_f32 v126, v62, v210
  v_fmac_f32 v127, v63, v210
  v_fmac_f32 v128, v64, v210
  v_fmac_f32 v129, v65, v210
  v_fmac_f32 v130, v66, v210
  v_fmac_f32 v131, v67, v210
  v_fmac_f32 v132, v68, v210
  v_fmac_f32 v133, v69, v210
  v_fmac_f32 v134, v70, v210
  v_fmac_f32 v135, v71, v210
  v_cvt_pk_bf16_f32 v176, v120, v121
  v_cvt_pk_bf16_f32 v177, v122, v123
  v_cvt_pk_bf16_f32 v178, v124, v125
  v_cvt_pk_bf16_f32 v179, v126, v127
  buffer_store_dwordx4 v[176:179], v8, s[40:43], s50 offen offset:2048 sc1
  v_cvt_pk_bf16_f32 v180, v128, v129
  v_cvt_pk_bf16_f32 v181, v130, v131
  v_cvt_pk_bf16_f32 v182, v132, v133
  v_cvt_pk_bf16_f32 v183, v134, v135
  buffer_store_dwordx4 v[180:183], v8, s[40:43], s50 offen offset:2560 sc1
  s_mov_b32 s50, 12288
  s_waitcnt lgkmcnt(4)
  v_mul_f32 v136, v136, v209
  v_mul_f32 v137, v137, v209
  v_mul_f32 v138, v138, v209
  v_mul_f32 v139, v139, v209
  v_mul_f32 v140, v140, v209
  v_mul_f32 v141, v141, v209
  v_mul_f32 v142, v142, v209
  v_mul_f32 v143, v143, v209
  v_mul_f32 v144, v144, v209
  v_mul_f32 v145, v145, v209
  v_mul_f32 v146, v146, v209
  v_mul_f32 v147, v147, v209
  v_mul_f32 v148, v148, v209
  v_mul_f32 v149, v149, v209
  v_mul_f32 v150, v150, v209
  v_mul_f32 v151, v151, v209
  v_fmac_f32 v136, v72, v208
  v_fmac_f32 v137, v73, v208
  v_fmac_f32 v138, v74, v208
  v_fmac_f32 v139, v75, v208
  v_fmac_f32 v140, v76, v208
  v_fmac_f32 v141, v77, v208
  v_fmac_f32 v142, v78, v208
  v_fmac_f32 v143, v79, v208
  v_fmac_f32 v144, v80, v208
  v_fmac_f32 v145, v81, v208
  v_fmac_f32 v146, v82, v208
  v_fmac_f32 v147, v83, v208
  v_fmac_f32 v148, v84, v208
  v_fmac_f32 v149, v85, v208
  v_fmac_f32 v150, v86, v208
  v_fmac_f32 v151, v87, v208
  v_cvt_pk_bf16_f32 v184, v136, v137
  v_cvt_pk_bf16_f32 v185, v138, v139
  v_cvt_pk_bf16_f32 v186, v140, v141
  v_cvt_pk_bf16_f32 v187, v142, v143
  buffer_store_dwordx4 v[184:187], v8, s[40:43], s50 offen offset:0 sc1
  v_cvt_pk_bf16_f32 v188, v144, v145
  v_cvt_pk_bf16_f32 v189, v146, v147
  v_cvt_pk_bf16_f32 v190, v148, v149
  v_cvt_pk_bf16_f32 v191, v150, v151
  buffer_store_dwordx4 v[188:191], v8, s[40:43], s50 offen offset:512 sc1
  s_waitcnt lgkmcnt(0)
  v_mul_f32 v152, v152, v211
  v_mul_f32 v153, v153, v211
  v_mul_f32 v154, v154, v211
  v_mul_f32 v155, v155, v211
  v_mul_f32 v156, v156, v211
  v_mul_f32 v157, v157, v211
  v_mul_f32 v158, v158, v211
  v_mul_f32 v159, v159, v211
  v_mul_f32 v160, v160, v211
  v_mul_f32 v161, v161, v211
  v_mul_f32 v162, v162, v211
  v_mul_f32 v163, v163, v211
  v_mul_f32 v164, v164, v211
  v_mul_f32 v165, v165, v211
  v_mul_f32 v166, v166, v211
  v_mul_f32 v167, v167, v211
  v_fmac_f32 v152, v88, v210
  v_fmac_f32 v153, v89, v210
  v_fmac_f32 v154, v90, v210
  v_fmac_f32 v155, v91, v210
  v_fmac_f32 v156, v92, v210
  v_fmac_f32 v157, v93, v210
  v_fmac_f32 v158, v94, v210
  v_fmac_f32 v159, v95, v210
  v_fmac_f32 v160, v96, v210
  v_fmac_f32 v161, v97, v210
  v_fmac_f32 v162, v98, v210
  v_fmac_f32 v163, v99, v210
  v_fmac_f32 v164, v100, v210
  v_fmac_f32 v165, v101, v210
  v_fmac_f32 v166, v102, v210
  v_fmac_f32 v167, v103, v210
  v_cvt_pk_bf16_f32 v192, v152, v153
  v_cvt_pk_bf16_f32 v193, v154, v155
  v_cvt_pk_bf16_f32 v194, v156, v157
  v_cvt_pk_bf16_f32 v195, v158, v159
  buffer_store_dwordx4 v[192:195], v8, s[40:43], s50 offen offset:2048 sc1
  v_cvt_pk_bf16_f32 v196, v160, v161
  v_cvt_pk_bf16_f32 v197, v162, v163
  v_cvt_pk_bf16_f32 v198, v164, v165
  v_cvt_pk_bf16_f32 v199, v166, v167
  buffer_store_dwordx4 v[196:199], v8, s[40:43], s50 offen offset:2560 sc1
  s_branch L_k1_fin
L_k1_fin:
  s_load_dwordx2 s[8:9], s[0:1], 80
  v_lshlrev_b32 v20, 4, v1
  s_add_u32 m0, s47, 23552
  s_nop 0
  buffer_load_dwordx4 v224, s[96:99], s92 offen  lds
  s_add_u32 m0, s47, 24576
  s_nop 0
  buffer_load_dwordx4 v225, s[96:99], s92 offen  lds
  s_add_u32 m0, s47, 25600
  s_nop 0
  buffer_load_dwordx4 v226, s[96:99], s92 offen  lds
  s_add_u32 m0, s47, 26624
  s_nop 0
  buffer_load_dwordx4 v227, s[96:99], s92 offen  lds
  s_add_u32 m0, s47, 27648
  s_nop 0
  buffer_load_dwordx4 v228, s[96:99], s92 offen  lds
  s_add_u32 m0, s47, 28672
  s_nop 0
  buffer_load_dwordx4 v229, s[96:99], s92 offen  lds
  s_add_u32 m0, s47, 29696
  s_nop 0
  buffer_load_dwordx4 v230, s[96:99], s92 offen  lds
  s_add_u32 m0, s47, 30720
  s_nop 0
  buffer_load_dwordx4 v231, s[96:99], s92 offen  lds
  s_add_u32 m0, s47, 31744
  s_nop 0
  buffer_load_dwordx4 v232, s[96:99], s92 offen  lds
  s_lshl_b32 s50, s88, 1
  s_add_u32 s50, s50, s57
  s_lshl_b32 s51, s50, 3
  s_lshl_b32 s52, s89, 1
  s_add_u32 s51, s51, s52
  s_lshr_b32 s52, s44, 1
  s_add_u32 s51, s51, s52
  s_lshl_b32 s51, s51, 16
  s_and_b32 s52, s44, 1
  s_lshl_b32 s52, s52, 11
  s_add_u32 s51, s51, s52
  s_add_u32 s28, s20, s51
  s_addc_u32 s29, s21, 0
  s_and_b32 s29, s29, 0xffff
  s_mov_b32 s30, 0x10000
  s_mov_b32 s31, 0x20000
  s_lshl_b32 s50, s50, 2
  s_add_u32 s50, s50, s89
  s_lshl_b32 s50, s50, 2
  s_add_u32 s50, s50, s90
  s_lshl_b32 s50, s50, 2
  s_add_u32 s50, s50, s44
  s_mul_i32 s50, s50, 9216
  s_add_u32 s50, s50, 16777216
  s_add_u32 s32, s20, s50
  s_addc_u32 s33, s21, 0
  s_and_b32 s33, s33, 0xffff
  s_mov_b32 s34, 9216
  s_mov_b32 s35, 0x20000
  v_lshrrev_b32 v2, 5, v1
  v_lshlrev_b32 v2, 4, v2
  v_bfe_u32 v3, v1, 4, 1
  v_lshlrev_b32 v3, 2, v3
  v_add_u32 v2, v2, v3
  v_bfe_u32 v3, v1, 2, 2
  v_add_u32 v2, v2, v3
  v_mul_u32_u24 v2, 288, v2
  v_and_b32 v3, 3, v1
  v_lshlrev_b32 v3, 3, v3
  v_add_u32 v19, v2, v3
  v_add_u32 v21, 0x10000, v19
  v_add_u32 v22, 0x20000, v19
  v_mov_b32 v48, 0
  v_mov_b32 v49, 0
  v_mov_b32 v50, 0
  v_mov_b32 v51, 0
  v_mov_b32 v52, 0
  v_mov_b32 v53, 0
  v_mov_b32 v54, 0
  v_mov_b32 v55, 0
  v_mov_b32 v56, 0
  v_mov_b32 v57, 0
  v_mov_b32 v58, 0
  v_mov_b32 v59, 0
  v_mov_b32 v60, 0
  v_mov_b32 v61, 0
  v_mov_b32 v62, 0
  v_mov_b32 v63, 0
  v_mov_b32 v64, 0
  v_mov_b32 v65, 0
  v_mov_b32 v66, 0
  v_mov_b32 v67, 0
  v_mov_b32 v68, 0
  v_mov_b32 v69, 0
  v_mov_b32 v70, 0
  v_mov_b32 v71, 0
  v_mov_b32 v72, 0
  v_mov_b32 v73, 0
  v_mov_b32 v74, 0
  v_mov_b32 v75, 0
  v_mov_b32 v76, 0
  v_mov_b32 v77, 0
  v_mov_b32 v78, 0
  v_mov_b32 v79, 0
  v_mov_b32 v80, 0
  v_mov_b32 v81, 0
  v_mov_b32 v82, 0
  v_mov_b32 v83, 0
  v_mov_b32 v84, 0
  v_mov_b32 v85, 0
  v_mov_b32 v86, 0
  v_mov_b32 v87, 0
  v_mov_b32 v88, 0
  v_mov_b32 v89, 0
  v_mov_b32 v90, 0
  v_mov_b32 v91, 0
  v_mov_b32 v92, 0
  v_mov_b32 v93, 0
  v_mov_b32 v94, 0
  v_mov_b32 v95, 0
  v_mov_b32 v96, 0
  v_mov_b32 v97, 0
  v_mov_b32 v98, 0
  v_mov_b32 v99, 0
  v_mov_b32 v100, 0
  v_mov_b32 v101, 0
  v_mov_b32 v102, 0
  v_mov_b32 v103, 0
  v_mov_b32 v104, 0
  v_mov_b32 v105, 0
  v_mov_b32 v106, 0
  v_mov_b32 v107, 0
  v_mov_b32 v108, 0
  v_mov_b32 v109, 0
  v_mov_b32 v110, 0
  v_mov_b32 v111, 0
  v_mov_b32 v112, 0
  v_mov_b32 v113, 0
  v_mov_b32 v114, 0
  v_mov_b32 v115, 0
  v_mov_b32 v116, 0
  v_mov_b32 v117, 0
  v_mov_b32 v118, 0
  v_mov_b32 v119, 0
  s_waitcnt vmcnt(9)
  s_barrier
  s_lshl_b32 s50, s88, 1
  s_add_u32 s50, s50, s57
  s_lshl_b32 s50, s50, 2
  s_add_u32 s50, s50, s89
  s_lshl_b32 s50, s50, 7
  s_add_u32 s50, s50, 50331648
  s_mov_b32 s51, s90
  s_mov_b32 s43, s50
  s_cmp_lg_u32 s44, 0
  s_cbranch_scc1 L_h1_nopub
  s_lshl_b32 s51, s51, 2
  s_add_u32 s51, s51, s50
  v_mov_b32 v2, s51
  v_mov_b32 v3, s62
  s_mov_b64 s[40:41], exec
  s_mov_b64 exec, 1
  global_store_dword v2, v3, s[20:21] sc1
  s_mov_b64 exec, s[40:41]
L_h1_nopub:
  s_add_u32 m0, s47, 0
  s_nop 0
  buffer_load_dwordx4 v224, s[96:99], s93 offen  lds
  s_add_u32 m0, s47, 1024
  s_nop 0
  buffer_load_dwordx4 v225, s[96:99], s93 offen  lds
  s_add_u32 m0, s47, 2048
  s_nop 0
  buffer_load_dwordx4 v226, s[96:99], s93 offen  lds
  s_add_u32 m0, s47, 3072
  s_nop 0
  buffer_load_dwordx4 v227, s[96:99], s93 offen  lds
  s_add_u32 m0, s47, 4096
  s_nop 0
  buffer_load_dwordx4 v228, s[96:99], s93 offen  lds
  s_add_u32 m0, s47, 5120
  s_nop 0
  buffer_load_dwordx4 v229, s[96:99], s93 offen  lds
  s_add_u32 m0, s47, 6144
  s_nop 0
  buffer_load_dwordx4 v230, s[96:99], s93 offen  lds
  s_add_u32 m0, s47, 7168
  s_nop 0
  buffer_load_dwordx4 v231, s[96:99], s93 offen  lds
  s_add_u32 m0, s47, 8192
  s_nop 0
  buffer_load_dwordx4 v232, s[96:99], s93 offen  lds
  s_add_u32 m0, s47, 9216
  s_nop 0
  buffer_load_dwordx4 v224, s[96:99], s94 offen  lds
  s_add_u32 m0, s47, 10240
  s_nop 0
  buffer_load_dwordx4 v225, s[96:99], s94 offen  lds
  s_add_u32 m0, s47, 11264
  s_nop 0
  buffer_load_dwordx4 v226, s[96:99], s94 offen  lds
  s_add_u32 m0, s47, 12288
  s_nop 0
  buffer_load_dwordx4 v227, s[96:99], s94 offen  lds
  s_add_u32 m0, s47, 13312
  s_nop 0
  buffer_load_dwordx4 v228, s[96:99], s94 offen  lds
  s_add_u32 m0, s47, 14336
  s_nop 0
  buffer_load_dwordx4 v229, s[96:99], s94 offen  lds
  s_add_u32 m0, s47, 15360
  s_nop 0
  buffer_load_dwordx4 v230, s[96:99], s94 offen  lds
  s_add_u32 m0, s47, 16384
  s_nop 0
  buffer_load_dwordx4 v231, s[96:99], s94 offen  lds
  s_add_u32 m0, s47, 17408
  s_nop 0
  buffer_load_dwordx4 v232, s[96:99], s94 offen  lds
  s_and_b32 s50, s44, 2
  v_and_b32 v4, 1, v1
  v_or_b32 v4, s50, v4
  v_lshlrev_b32 v4, 2, v4
  v_add_u32 v4, s43, v4
  s_mov_b32 s52, 131072
  global_load_dword v5, v4, s[20:21] sc1
L_h1_poll:
  global_load_dword v3, v4, s[20:21] sc1
  s_waitcnt vmcnt(1)
  v_cmp_ne_u32 vcc, s62, v5
  s_cbranch_vccz L_h1_ok
  global_load_dword v5, v4, s[20:21] sc1
  s_waitcnt vmcnt(1)
  v_cmp_ne_u32 vcc, s62, v3
  s_cbranch_vccz L_h1_ok
  s_sub_u32 s52, s52, 1
  s_cmp_lg_u32 s52, 0
  s_cbranch_scc1 L_h1_poll
L_h1_ok:
  s_add_u32 s50, s91, 0
  s_and_b32 s50, s50, 15
  s_lshl_b32 s50, s50, 12
  buffer_load_dwordx4 v[120:123], v20, s[28:31], s50 offen offset:0 sc1
  buffer_load_dwordx4 v[124:127], v20, s[28:31], s50 offen offset:1024 sc1
  s_add_u32 s50, s91, 1
  s_and_b32 s50, s50, 15
  s_lshl_b32 s50, s50, 12
  buffer_load_dwordx4 v[128:131], v20, s[28:31], s50 offen offset:0 sc1
  buffer_load_dwordx4 v[132:135], v20, s[28:31], s50 offen offset:1024 sc1
  s_add_u32 s50, s91, 2
  s_and_b32 s50, s50, 15
  s_lshl_b32 s50, s50, 12
  buffer_load_dwordx4 v[136:139], v20, s[28:31], s50 offen offset:0 sc1
  buffer_load_dwordx4 v[140:143], v20, s[28:31], s50 offen offset:1024 sc1
  s_add_u32 s50, s91, 3
  s_and_b32 s50, s50, 15
  s_lshl_b32 s50, s50, 12
  buffer_load_dwordx4 v[144:147], v20, s[28:31], s50 offen offset:0 sc1
  buffer_load_dwordx4 v[148:151], v20, s[28:31], s50 offen offset:1024 sc1
  s_barrier
  ds_read_b64_tr_b16 v[24:25], v19 offset:23552
  ds_read_b64_tr_b16 v[26:27], v19 offset:25856
  ds_read_b64_tr_b16 v[28:29], v19 offset:23584
  ds_read_b64_tr_b16 v[30:31], v19 offset:25888
  ds_read_b64_tr_b16 v[32:33], v19 offset:23616
  ds_read_b64_tr_b16 v[34:35], v19 offset:25920
  ds_read_b64_tr_b16 v[36:37], v19 offset:23648
  ds_read_b64_tr_b16 v[38:39], v19 offset:25952
  s_waitcnt vmcnt(6)
  s_waitcnt lgkmcnt(6)
  v_mfma_f32_16x16x32_bf16 v[48:51], v[24:27], v[120:123], v[48:51]
  v_mfma_f32_16x16x32_bf16 v[52:55], v[24:27], v[124:127], v[52:55]
  ds_read_b64_tr_b16 v[40:41], v19 offset:23680
  ds_read_b64_tr_b16 v[42:43], v19 offset:25984
  s_waitcnt lgkmcnt(6)
  v_mfma_f32_16x16x32_bf16 v[56:59], v[28:31], v[120:123], v[56:59]
  v_mfma_f32_16x16x32_bf16 v[60:63], v[28:31], v[124:127], v[60:63]
  ds_read_b64_tr_b16 v[24:25], v19 offset:23712
  ds_read_b64_tr_b16 v[26:27], v19 offset:26016
  s_add_u32 s50, s91, 4
  s_and_b32 s50, s50, 15
  s_lshl_b32 s50, s50, 12
  buffer_load_dwordx4 v[152:155], v20, s[28:31], s50 offen offset:0 sc1
  s_waitcnt lgkmcnt(6)
  v_mfma_f32_16x16x32_bf16 v[64:67], v[32:35], v[120:123], v[64:67]
  v_mfma_f32_16x16x32_bf16 v[68:71], v[32:35], v[124:127], v[68:71]
  ds_read_b64_tr_b16 v[28:29], v19 offset:23744
  ds_read_b64_tr_b16 v[30:31], v19 offset:26048
  s_waitcnt lgkmcnt(6)
  v_mfma_f32_16x16x32_bf16 v[72:75], v[36:39], v[120:123], v[72:75]
  v_mfma_f32_16x16x32_bf16 v[76:79], v[36:39], v[124:127], v[76:79]
  ds_read_b64_tr_b16 v[32:33], v19 offset:23776
  ds_read_b64_tr_b16 v[34:35], v19 offset:26080
  buffer_load_dwordx4 v[156:159], v20, s[28:31], s50 offen offset:1024 sc1
  s_waitcnt lgkmcnt(6)
  v_mfma_f32_16x16x32_bf16 v[80:83], v[40:43], v[120:123], v[80:83]
  v_mfma_f32_16x16x32_bf16 v[84:87], v[40:43], v[124:127], v[84:87]
  ds_read_b64_tr_b16 v[36:37], v19 offset:23808
  ds_read_b64_tr_b16 v[38:39], v19 offset:26112
  s_waitcnt lgkmcnt(6)
  v_mfma_f32_16x16x32_bf16 v[88:91], v[24:27], v[120:123], v[88:91]
  v_mfma_f32_16x16x32_bf16 v[92:95], v[24:27], v[124:127], v[92:95]
  ds_read_b64_tr_b16 v[40:41], v19 offset:56320
  ds_read_b64_tr_b16 v[42:43], v19 offset:58624
  s_add_u32 s50, s91, 5
  s_and_b32 s50, s50, 15
  s_lshl_b32 s50, s50, 12
  buffer_load_dwordx4 v[160:163], v20, s[28:31], s50 offen offset:0 sc1
  s_waitcnt lgkmcnt(6)
  v_mfma_f32_16x16x32_bf16 v[96:99], v[28:31], v[120:123], v[96:99]
  v_mfma_f32_16x16x32_bf16 v[100:103], v[28:31], v[124:127], v[100:103]
  ds_read_b64_tr_b16 v[24:25], v19 offset:56352
  ds_read_b64_tr_b16 v[26:27], v19 offset:58656
  s_waitcnt lgkmcnt(6)
  v_mfma_f32_16x16x32_bf16 v[104:107], v[32:35], v[120:123], v[104:107]
  v_mfma_f32_16x16x32_bf16 v[108:111], v[32:35], v[124:127], v[108:111]
  ds_read_b64_tr_b16 v[28:29], v19 offset:56384
  ds_read_b64_tr_b16 v[30:31], v19 offset:58688
  buffer_load_dwordx4 v[164:167], v20, s[28:31], s50 offen offset:1024 sc1
  s_waitcnt lgkmcnt(6)
  v_mfma_f32_16x16x32_bf16 v[112:115], v[36:39], v[120:123], v[112:115]
  v_mfma_f32_16x16x32_bf16 v[116:119], v[36:39], v[124:127], v[116:119]
  ds_read_b64_tr_b16 v[32:33], v19 offset:56416
  ds_read_b64_tr_b16 v[34:35], v19 offset:58720
  s_waitcnt vmcnt(8)
  s_waitcnt lgkmcnt(6)
  v_mfma_f32_16x16x32_bf16 v[48:51], v[40:43], v[128:131], v[48:51]
  v_mfma_f32_16x16x32_bf16 v[52:55], v[40:43], v[132:135], v[52:55]
  ds_read_b64_tr_b16 v[36:37], v19 offset:56448
  ds_read_b64_tr_b16 v[38:39], v19 offset:58752
  s_add_u32 s50, s91, 6
  s_and_b32 s50, s50, 15
  s_lshl_b32 s50, s50, 12
  buffer_load_dwordx4 v[168:171], v20, s[28:31], s50 offen offset:0 sc1
  s_waitcnt lgkmcnt(6)
  v_mfma_f32_16x16x32_bf16 v[56:59], v[24:27], v[128:131], v[56:59]
  v_mfma_f32_16x16x32_bf16 v[60:63], v[24:27], v[132:135], v[60:63]
  ds_read_b64_tr_b16 v[40:41], v19 offset:56480
  ds_read_b64_tr_b16 v[42:43], v19 offset:58784
  s_waitcnt lgkmcnt(6)
  v_mfma_f32_16x16x32_bf16 v[64:67], v[28:31], v[128:131], v[64:67]
  v_mfma_f32_16x16x32_bf16 v[68:71], v[28:31], v[132:135], v[68:71]
  ds_read_b64_tr_b16 v[24:25], v19 offset:56512
  ds_read_b64_tr_b16 v[26:27], v19 offset:58816
  buffer_load_dwordx4 v[172:175], v20, s[28:31], s50 offen offset:1024 sc1
  s_waitcnt lgkmcnt(6)
  v_mfma_f32_16x16x32_bf16 v[72:75], v[32:35], v[128:131], v[72:75]
  v_mfma_f32_16x16x32_bf16 v[76:79], v[32:35], v[132:135], v[76:79]
  ds_read_b64_tr_b16 v[28:29], v19 offset:56544
  ds_read_b64_tr_b16 v[30:31], v19 offset:58848
  s_waitcnt lgkmcnt(6)
  v_mfma_f32_16x16x32_bf16 v[80:83], v[36:39], v[128:131], v[80:83]
  v_mfma_f32_16x16x32_bf16 v[84:87], v[36:39], v[132:135], v[84:87]
  ds_read_b64_tr_b16 v[32:33], v19 offset:56576
  ds_read_b64_tr_b16 v[34:35], v19 offset:58880
  s_add_u32 s50, s91, 7
  s_and_b32 s50, s50, 15
  s_lshl_b32 s50, s50, 12
  buffer_load_dwordx4 v[176:179], v20, s[28:31], s50 offen offset:0 sc1
  s_waitcnt lgkmcnt(6)
  v_mfma_f32_16x16x32_bf16 v[88:91], v[40:43], v[128:131], v[88:91]
  v_mfma_f32_16x16x32_bf16 v[92:95], v[40:43], v[132:135], v[92:95]
  ds_read_b64_tr_b16 v[36:37], v21 offset:23552
  ds_read_b64_tr_b16 v[38:39], v21 offset:25856
  s_waitcnt lgkmcnt(6)
  v_mfma_f32_16x16x32_bf16 v[96:99], v[24:27], v[128:131], v[96:99]
  v_mfma_f32_16x16x32_bf16 v[100:103], v[24:27], v[132:135], v[100:103]
  ds_read_b64_tr_b16 v[40:41], v21 offset:23584
  ds_read_b64_tr_b16 v[42:43], v21 offset:25888
  buffer_load_dwordx4 v[180:183], v20, s[28:31], s50 offen offset:1024 sc1
  s_waitcnt lgkmcnt(6)
  v_mfma_f32_16x16x32_bf16 v[104:107], v[28:31], v[128:131], v[104:107]
  v_mfma_f32_16x16x32_bf16 v[108:111], v[28:31], v[132:135], v[108:111]
  ds_read_b64_tr_b16 v[24:25], v21 offset:23616
  ds_read_b64_tr_b16 v[26:27], v21 offset:25920
  s_waitcnt lgkmcnt(6)
  v_mfma_f32_16x16x32_bf16 v[112:115], v[32:35], v[128:131], v[112:115]
  v_mfma_f32_16x16x32_bf16 v[116:119], v[32:35], v[132:135], v[116:119]
  ds_read_b64_tr_b16 v[28:29], v21 offset:23648
  ds_read_b64_tr_b16 v[30:31], v21 offset:25952
  s_waitcnt vmcnt(10)
  s_waitcnt lgkmcnt(6)
  v_mfma_f32_16x16x32_bf16 v[48:51], v[36:39], v[136:139], v[48:51]
  v_mfma_f32_16x16x32_bf16 v[52:55], v[36:39], v[140:143], v[52:55]
  ds_read_b64_tr_b16 v[32:33], v21 offset:23680
  ds_read_b64_tr_b16 v[34:35], v21 offset:25984
  s_waitcnt lgkmcnt(6)
  v_mfma_f32_16x16x32_bf16 v[56:59], v[40:43], v[136:139], v[56:59]
  v_mfma_f32_16x16x32_bf16 v[60:63], v[40:43], v[140:143], v[60:63]
  ds_read_b64_tr_b16 v[36:37], v21 offset:23712
  ds_read_b64_tr_b16 v[38:39], v21 offset:26016
  s_waitcnt lgkmcnt(6)
  v_mfma_f32_16x16x32_bf16 v[64:67], v[24:27], v[136:139], v[64:67]
  v_mfma_f32_16x16x32_bf16 v[68:71], v[24:27], v[140:143], v[68:71]
  ds_read_b64_tr_b16 v[40:41], v21 offset:23744
  ds_read_b64_tr_b16 v[42:43], v21 offset:26048
  s_waitcnt lgkmcnt(6)
  v_mfma_f32_16x16x32_bf16 v[72:75], v[28:31], v[136:139], v[72:75]
  v_mfma_f32_16x16x32_bf16 v[76:79], v[28:31], v[140:143], v[76:79]
  ds_read_b64_tr_b16 v[24:25], v21 offset:23776
  ds_read_b64_tr_b16 v[26:27], v21 offset:26080
  s_waitcnt lgkmcnt(6)
  v_mfma_f32_16x16x32_bf16 v[80:83], v[32:35], v[136:139], v[80:83]
  v_mfma_f32_16x16x32_bf16 v[84:87], v[32:35], v[140:143], v[84:87]
  ds_read_b64_tr_b16 v[28:29], v21 offset:23808
  ds_read_b64_tr_b16 v[30:31], v21 offset:26112
  s_waitcnt lgkmcnt(6)
  v_mfma_f32_16x16x32_bf16 v[88:91], v[36:39], v[136:139], v[88:91]
  v_mfma_f32_16x16x32_bf16 v[92:95], v[36:39], v[140:143], v[92:95]
  ds_read_b64_tr_b16 v[32:33], v21 offset:56320
  ds_read_b64_tr_b16 v[34:35], v21 offset:58624
  s_waitcnt lgkmcnt(6)
  v_mfma_f32_16x16x32_bf16 v[96:99], v[40:43], v[136:139], v[96:99]
  v_mfma_f32_16x16x32_bf16 v[100:103], v[40:43], v[140:143], v[100:103]
  ds_read_b64_tr_b16 v[36:37], v21 offset:56352
  ds_read_b64_tr_b16 v[38:39], v21 offset:58656
  s_waitcnt lgkmcnt(6)
  v_mfma_f32_16x16x32_bf16 v[104:107], v[24:27], v[136:139], v[104:107]
  v_mfma_f32_16x16x32_bf16 v[108:111], v[24:27], v[140:143], v[108:111]
  ds_read_b64_tr_b16 v[40:41], v21 offset:56384
  ds_read_b64_tr_b16 v[42:43], v21 offset:58688
  s_waitcnt lgkmcnt(6)
  v_mfma_f32_16x16x32_bf16 v[112:115], v[28:31], v[136:139], v[112:115]
  v_mfma_f32_16x16x32_bf16 v[116:119], v[28:31], v[140:143], v[116:119]
  ds_read_b64_tr_b16 v[24:25], v21 offset:56416
  ds_read_b64_tr_b16 v[26:27], v21 offset:58720
  s_waitcnt vmcnt(8)
  s_waitcnt lgkmcnt(6)
  v_mfma_f32_16x16x32_bf16 v[48:51], v[32:35], v[144:147], v[48:51]
  v_mfma_f32_16x16x32_bf16 v[52:55], v[32:35], v[148:151], v[52:55]
  ds_read_b64_tr_b16 v[28:29], v21 offset:56448
  ds_read_b64_tr_b16 v[30:31], v21 offset:58752
  s_waitcnt lgkmcnt(6)
  v_mfma_f32_16x16x32_bf16 v[56:59], v[36:39], v[144:147], v[56:59]
  v_mfma_f32_16x16x32_bf16 v[60:63], v[36:39], v[148:151], v[60:63]
  ds_read_b64_tr_b16 v[32:33], v21 offset:56480
  ds_read_b64_tr_b16 v[34:35], v21 offset:58784
  s_waitcnt lgkmcnt(6)
  v_mfma_f32_16x16x32_bf16 v[64:67], v[40:43], v[144:147], v[64:67]
  v_mfma_f32_16x16x32_bf16 v[68:71], v[40:43], v[148:151], v[68:71]
  ds_read_b64_tr_b16 v[36:37], v21 offset:56512
  ds_read_b64_tr_b16 v[38:39], v21 offset:58816
  s_waitcnt lgkmcnt(6)
  v_mfma_f32_16x16x32_bf16 v[72:75], v[24:27], v[144:147], v[72:75]
  v_mfma_f32_16x16x32_bf16 v[76:79], v[24:27], v[148:151], v[76:79]
  ds_read_b64_tr_b16 v[40:41], v21 offset:56544
  ds_read_b64_tr_b16 v[42:43], v21 offset:58848
  s_waitcnt lgkmcnt(6)
  v_mfma_f32_16x16x32_bf16 v[80:83], v[28:31], v[144:147], v[80:83]
  v_mfma_f32_16x16x32_bf16 v[84:87], v[28:31], v[148:151], v[84:87]
  ds_read_b64_tr_b16 v[24:25], v21 offset:56576
  ds_read_b64_tr_b16 v[26:27], v21 offset:58880
  s_waitcnt lgkmcnt(6)
  v_mfma_f32_16x16x32_bf16 v[88:91], v[32:35], v[144:147], v[88:91]
  v_mfma_f32_16x16x32_bf16 v[92:95], v[32:35], v[148:151], v[92:95]
  ds_read_b64_tr_b16 v[28:29], v19 offset:0
  ds_read_b64_tr_b16 v[30:31], v19 offset:2304
  s_waitcnt lgkmcnt(6)
  v_mfma_f32_16x16x32_bf16 v[96:99], v[36:39], v[144:147], v[96:99]
  v_mfma_f32_16x16x32_bf16 v[100:103], v[36:39], v[148:151], v[100:103]
  ds_read_b64_tr_b16 v[32:33], v19 offset:32
  ds_read_b64_tr_b16 v[34:35], v19 offset:2336
  s_waitcnt lgkmcnt(6)
  v_mfma_f32_16x16x32_bf16 v[104:107], v[40:43], v[144:147], v[104:107]
  v_mfma_f32_16x16x32_bf16 v[108:111], v[40:43], v[148:151], v[108:111]
  ds_read_b64_tr_b16 v[36:37], v19 offset:64
  ds_read_b64_tr_b16 v[38:39], v19 offset:2368
  s_waitcnt lgkmcnt(6)
  v_mfma_f32_16x16x32_bf16 v[112:115], v[24:27], v[144:147], v[112:115]
  v_mfma_f32_16x16x32_bf16 v[116:119], v[24:27], v[148:151], v[116:119]
  ds_read_b64_tr_b16 v[40:41], v19 offset:96
  ds_read_b64_tr_b16 v[42:43], v19 offset:2400
  s_barrier
  s_waitcnt vmcnt(6)
  s_waitcnt lgkmcnt(6)
  v_mfma_f32_16x16x32_bf16 v[48:51], v[28:31], v[152:155], v[48:51]
  v_mfma_f32_16x16x32_bf16 v[52:55], v[28:31], v[156:159], v[52:55]
  ds_read_b64_tr_b16 v[24:25], v19 offset:128
  ds_read_b64_tr_b16 v[26:27], v19 offset:2432
  s_waitcnt lgkmcnt(6)
  v_mfma_f32_16x16x32_bf16 v[56:59], v[32:35], v[152:155], v[56:59]
  v_mfma_f32_16x16x32_bf16 v[60:63], v[32:35], v[156:159], v[60:63]
  ds_read_b64_tr_b16 v[28:29], v19 offset:160
  ds_read_b64_tr_b16 v[30:31], v19 offset:2464
  s_add_u32 m0, s47, 23552
  s_nop 0
  buffer_load_dwordx4 v224, s[96:99], s95 offen  lds
  s_waitcnt lgkmcnt(6)
  v_mfma_f32_16x16x32_bf16 v[64:67], v[36:39], v[152:155], v[64:67]
  v_mfma_f32_16x16x32_bf16 v[68:71], v[36:39], v[156:159], v[68:71]
  ds_read_b64_tr_b16 v[32:33], v19 offset:192
  ds_read_b64_tr_b16 v[34:35], v19 offset:2496
  s_waitcnt lgkmcnt(6)
  v_mfma_f32_16x16x32_bf16 v[72:75], v[40:43], v[152:155], v[72:75]
  v_mfma_f32_16x16x32_bf16 v[76:79], v[40:43], v[156:159], v[76:79]
  ds_read_b64_tr_b16 v[36:37], v19 offset:224
  ds_read_b64_tr_b16 v[38:39], v19 offset:2528
  s_add_u32 m0, s47, 24576
  s_nop 0
  buffer_load_dwordx4 v225, s[96:99], s95 offen  lds
  s_waitcnt lgkmcnt(6)
  v_mfma_f32_16x16x32_bf16 v[80:83], v[24:27], v[152:155], v[80:83]
  v_mfma_f32_16x16x32_bf16 v[84:87], v[24:27], v[156:159], v[84:87]
  ds_read_b64_tr_b16 v[40:41], v19 offset:256
  ds_read_b64_tr_b16 v[42:43], v19 offset:2560
  s_waitcnt lgkmcnt(6)
  v_mfma_f32_16x16x32_bf16 v[88:91], v[28:31], v[152:155], v[88:91]
  v_mfma_f32_16x16x32_bf16 v[92:95], v[28:31], v[156:159], v[92:95]
  ds_read_b64_tr_b16 v[24:25], v19 offset:32768
  ds_read_b64_tr_b16 v[26:27], v19 offset:35072
  s_add_u32 m0, s47, 25600
  s_nop 0
  buffer_load_dwordx4 v226, s[96:99], s95 offen  lds
  s_waitcnt lgkmcnt(6)
  v_mfma_f32_16x16x32_bf16 v[96:99], v[32:35], v[152:155], v[96:99]
  v_mfma_f32_16x16x32_bf16 v[100:103], v[32:35], v[156:159], v[100:103]
  ds_read_b64_tr_b16 v[28:29], v19 offset:32800
  ds_read_b64_tr_b16 v[30:31], v19 offset:35104
  s_waitcnt lgkmcnt(6)
  v_mfma_f32_16x16x32_bf16 v[104:107], v[36:39], v[152:155], v[104:107]
  v_mfma_f32_16x16x32_bf16 v[108:111], v[36:39], v[156:159], v[108:111]
  ds_read_b64_tr_b16 v[32:33], v19 offset:32832
  ds_read_b64_tr_b16 v[34:35], v19 offset:35136
  s_add_u32 m0, s47, 26624
  s_nop 0
  buffer_load_dwordx4 v227, s[96:99], s95 offen  lds
  s_waitcnt lgkmcnt(6)
  v_mfma_f32_16x16x32_bf16 v[112:115], v[40:43], v[152:155], v[112:115]
  v_mfma_f32_16x16x32_bf16 v[116:119], v[40:43], v[156:159], v[116:119]
  ds_read_b64_tr_b16 v[36:37], v19 offset:32864
  ds_read_b64_tr_b16 v[38:39], v19 offset:35168
  s_waitcnt vmcnt(8)
  s_waitcnt lgkmcnt(6)
  v_mfma_f32_16x16x32_bf16 v[48:51], v[24:27], v[160:163], v[48:51]
  v_mfma_f32_16x16x32_bf16 v[52:55], v[24:27], v[164:167], v[52:55]
  ds_read_b64_tr_b16 v[40:41], v19 offset:32896
  ds_read_b64_tr_b16 v[42:43], v19 offset:35200
  s_add_u32 m0, s47, 27648
  s_nop 0
  buffer_load_dwordx4 v228, s[96:99], s95 offen  lds
  s_waitcnt lgkmcnt(6)
  v_mfma_f32_16x16x32_bf16 v[56:59], v[28:31], v[160:163], v[56:59]
  v_mfma_f32_16x16x32_bf16 v[60:63], v[28:31], v[164:167], v[60:63]
  ds_read_b64_tr_b16 v[24:25], v19 offset:32928
  ds_read_b64_tr_b16 v[26:27], v19 offset:35232
  s_waitcnt lgkmcnt(6)
  v_mfma_f32_16x16x32_bf16 v[64:67], v[32:35], v[160:163], v[64:67]
  v_mfma_f32_16x16x32_bf16 v[68:71], v[32:35], v[164:167], v[68:71]
  ds_read_b64_tr_b16 v[28:29], v19 offset:32960
  ds_read_b64_tr_b16 v[30:31], v19 offset:35264
  s_add_u32 m0, s47, 28672
  s_nop 0
  buffer_load_dwordx4 v229, s[96:99], s95 offen  lds
  s_waitcnt lgkmcnt(6)
  v_mfma_f32_16x16x32_bf16 v[72:75], v[36:39], v[160:163], v[72:75]
  v_mfma_f32_16x16x32_bf16 v[76:79], v[36:39], v[164:167], v[76:79]
  ds_read_b64_tr_b16 v[32:33], v19 offset:32992
  ds_read_b64_tr_b16 v[34:35], v19 offset:35296
  s_waitcnt lgkmcnt(6)
  v_mfma_f32_16x16x32_bf16 v[80:83], v[40:43], v[160:163], v[80:83]
  v_mfma_f32_16x16x32_bf16 v[84:87], v[40:43], v[164:167], v[84:87]
  ds_read_b64_tr_b16 v[36:37], v19 offset:33024
  ds_read_b64_tr_b16 v[38:39], v19 offset:35328
  s_add_u32 m0, s47, 29696
  s_nop 0
  buffer_load_dwordx4 v230, s[96:99], s95 offen  lds
  s_waitcnt lgkmcnt(6)
  v_mfma_f32_16x16x32_bf16 v[88:91], v[24:27], v[160:163], v[88:91]
  v_mfma_f32_16x16x32_bf16 v[92:95], v[24:27], v[164:167], v[92:95]
  ds_read_b64_tr_b16 v[40:41], v21 offset:0
  ds_read_b64_tr_b16 v[42:43], v21 offset:2304
  s_waitcnt lgkmcnt(6)
  v_mfma_f32_16x16x32_bf16 v[96:99], v[28:31], v[160:163], v[96:99]
  v_mfma_f32_16x16x32_bf16 v[100:103], v[28:31], v[164:167], v[100:103]
  ds_read_b64_tr_b16 v[24:25], v21 offset:32
  ds_read_b64_tr_b16 v[26:27], v21 offset:2336
  s_add_u32 m0, s47, 30720
  s_nop 0
  buffer_load_dwordx4 v231, s[96:99], s95 offen  lds
  s_waitcnt lgkmcnt(6)
  v_mfma_f32_16x16x32_bf16 v[104:107], v[32:35], v[160:163], v[104:107]
  v_mfma_f32_16x16x32_bf16 v[108:111], v[32:35], v[164:167], v[108:111]
  ds_read_b64_tr_b16 v[28:29], v21 offset:64
  ds_read_b64_tr_b16 v[30:31], v21 offset:2368
  s_waitcnt lgkmcnt(6)
  v_mfma_f32_16x16x32_bf16 v[112:115], v[36:39], v[160:163], v[112:115]
  v_mfma_f32_16x16x32_bf16 v[116:119], v[36:39], v[164:167], v[116:119]
  ds_read_b64_tr_b16 v[32:33], v21 offset:96
  ds_read_b64_tr_b16 v[34:35], v21 offset:2400
  s_add_u32 m0, s47, 31744
  s_nop 0
  buffer_load_dwordx4 v232, s[96:99], s95 offen  lds
  s_waitcnt vmcnt(11)
  s_waitcnt lgkmcnt(6)
  v_mfma_f32_16x16x32_bf16 v[48:51], v[40:43], v[168:171], v[48:51]
  v_mfma_f32_16x16x32_bf16 v[52:55], v[40:43], v[172:175], v[52:55]
  ds_read_b64_tr_b16 v[36:37], v21 offset:128
  ds_read_b64_tr_b16 v[38:39], v21 offset:2432
  s_waitcnt lgkmcnt(6)
  v_mfma_f32_16x16x32_bf16 v[56:59], v[24:27], v[168:171], v[56:59]
  v_mfma_f32_16x16x32_bf16 v[60:63], v[24:27], v[172:175], v[60:63]
  ds_read_b64_tr_b16 v[40:41], v21 offset:160
  ds_read_b64_tr_b16 v[42:43], v21 offset:2464
  s_add_u32 s50, s91, 8
  s_and_b32 s50, s50, 15
  s_lshl_b32 s50, s50, 12
  buffer_load_dwordx4 v[184:187], v20, s[28:31], s50 offen offset:0 sc1
  s_waitcnt lgkmcnt(6)
  v_mfma_f32_16x16x32_bf16 v[64:67], v[28:31], v[168:171], v[64:67]
  v_mfma_f32_16x16x32_bf16 v[68:71], v[28:31], v[172:175], v[68:71]
  ds_read_b64_tr_b16 v[24:25], v21 offset:192
  ds_read_b64_tr_b16 v[26:27], v21 offset:2496
  s_waitcnt lgkmcnt(6)
  v_mfma_f32_16x16x32_bf16 v[72:75], v[32:35], v[168:171], v[72:75]
  v_mfma_f32_16x16x32_bf16 v[76:79], v[32:35], v[172:175], v[76:79]
  ds_read_b64_tr_b16 v[28:29], v21 offset:224
  ds_read_b64_tr_b16 v[30:31], v21 offset:2528
  buffer_load_dwordx4 v[188:191], v20, s[28:31], s50 offen offset:1024 sc1
  s_waitcnt lgkmcnt(6)
  v_mfma_f32_16x16x32_bf16 v[80:83], v[36:39], v[168:171], v[80:83]
  v_mfma_f32_16x16x32_bf16 v[84:87], v[36:39], v[172:175], v[84:87]
  ds_read_b64_tr_b16 v[32:33], v21 offset:256
  ds_read_b64_tr_b16 v[34:35], v21 offset:2560
  s_waitcnt lgkmcnt(6)
  v_mfma_f32_16x16x32_bf16 v[88:91], v[40:43], v[168:171], v[88:91]
  v_mfma_f32_16x16x32_bf16 v[92:95], v[40:43], v[172:175], v[92:95]
  ds_read_b64_tr_b16 v[36:37], v21 offset:32768
  ds_read_b64_tr_b16 v[38:39], v21 offset:35072
  s_add_u32 s50, s91, 9
  s_and_b32 s50, s50, 15
  s_lshl_b32 s50, s50, 12
  buffer_load_dwordx4 v[192:195], v20, s[28:31], s50 offen offset:0 sc1
  s_waitcnt lgkmcnt(6)
  v_mfma_f32_16x16x32_bf16 v[96:99], v[24:27], v[168:171], v[96:99]
  v_mfma_f32_16x16x32_bf16 v[100:103], v[24:27], v[172:175], v[100:103]
  ds_read_b64_tr_b16 v[40:41], v21 offset:32800
  ds_read_b64_tr_b16 v[42:43], v21 offset:35104
  s_waitcnt lgkmcnt(6)
  v_mfma_f32_16x16x32_bf16 v[104:107], v[28:31], v[168:171], v[104:107]
  v_mfma_f32_16x16x32_bf16 v[108:111], v[28:31], v[172:175], v[108:111]
  ds_read_b64_tr_b16 v[24:25], v21 offset:32832
  ds_read_b64_tr_b16 v[26:27], v21 offset:35136
  buffer_load_dwordx4 v[196:199], v20, s[28:31], s50 offen offset:1024 sc1
  s_waitcnt lgkmcnt(6)
  v_mfma_f32_16x16x32_bf16 v[112:115], v[32:35], v[168:171], v[112:115]
  v_mfma_f32_16x16x32_bf16 v[116:119], v[32:35], v[172:175], v[116:119]
  ds_read_b64_tr_b16 v[28:29], v21 offset:32864
  ds_read_b64_tr_b16 v[30:31], v21 offset:35168
  s_waitcnt vmcnt(13)
  s_waitcnt lgkmcnt(6)
  v_mfma_f32_16x16x32_bf16 v[48:51], v[36:39], v[176:179], v[48:51]
  v_mfma_f32_16x16x32_bf16 v[52:55], v[36:39], v[180:183], v[52:55]
  ds_read_b64_tr_b16 v[32:33], v21 offset:32896
  ds_read_b64_tr_b16 v[34:35], v21 offset:35200
  s_add_u32 s50, s91, 10
  s_and_b32 s50, s50, 15
  s_lshl_b32 s50, s50, 12
  buffer_load_dwordx4 v[200:203], v20, s[28:31], s50 offen offset:0 sc1
  s_waitcnt lgkmcnt(6)
  v_mfma_f32_16x16x32_bf16 v[56:59], v[40:43], v[176:179], v[56:59]
  v_mfma_f32_16x16x32_bf16 v[60:63], v[40:43], v[180:183], v[60:63]
  ds_read_b64_tr_b16 v[36:37], v21 offset:32928
  ds_read_b64_tr_b16 v[38:39], v21 offset:35232
  s_waitcnt lgkmcnt(6)
  v_mfma_f32_16x16x32_bf16 v[64:67], v[24:27], v[176:179], v[64:67]
  v_mfma_f32_16x16x32_bf16 v[68:71], v[24:27], v[180:183], v[68:71]
  ds_read_b64_tr_b16 v[40:41], v21 offset:32960
  ds_read_b64_tr_b16 v[42:43], v21 offset:35264
  buffer_load_dwordx4 v[204:207], v20, s[28:31], s50 offen offset:1024 sc1
  s_waitcnt lgkmcnt(6)
  v_mfma_f32_16x16x32_bf16 v[72:75], v[28:31], v[176:179], v[72:75]
  v_mfma_f32_16x16x32_bf16 v[76:79], v[28:31], v[180:183], v[76:79]
  ds_read_b64_tr_b16 v[24:25], v21 offset:32992
  ds_read_b64_tr_b16 v[26:27], v21 offset:35296
  s_waitcnt lgkmcnt(6)
  v_mfma_f32_16x16x32_bf16 v[80:83], v[32:35], v[176:179], v[80:83]
  v_mfma_f32_16x16x32_bf16 v[84:87], v[32:35], v[180:183], v[84:87]
  ds_read_b64_tr_b16 v[28:29], v21 offset:33024
  ds_read_b64_tr_b16 v[30:31], v21 offset:35328
  s_add_u32 s50, s91, 11
  s_and_b32 s50, s50, 15
  s_lshl_b32 s50, s50, 12
  buffer_load_dwordx4 v[208:211], v20, s[28:31], s50 offen offset:0 sc1
  s_waitcnt lgkmcnt(6)
  v_mfma_f32_16x16x32_bf16 v[88:91], v[36:39], v[176:179], v[88:91]
  v_mfma_f32_16x16x32_bf16 v[92:95], v[36:39], v[180:183], v[92:95]
  ds_read_b64_tr_b16 v[32:33], v19 offset:9216
  ds_read_b64_tr_b16 v[34:35], v19 offset:11520
  s_waitcnt lgkmcnt(6)
  v_mfma_f32_16x16x32_bf16 v[96:99], v[40:43], v[176:179], v[96:99]
  v_mfma_f32_16x16x32_bf16 v[100:103], v[40:43], v[180:183], v[100:103]
  ds_read_b64_tr_b16 v[36:37], v19 offset:9248
  ds_read_b64_tr_b16 v[38:39], v19 offset:11552
  buffer_load_dwordx4 v[212:215], v20, s[28:31], s50 offen offset:1024 sc1
  s_waitcnt lgkmcnt(6)
  v_mfma_f32_16x16x32_bf16 v[104:107], v[24:27], v[176:179], v[104:107]
  v_mfma_f32_16x16x32_bf16 v[108:111], v[24:27], v[180:183], v[108:111]
  ds_read_b64_tr_b16 v[40:41], v19 offset:9280
  ds_read_b64_tr_b16 v[42:43], v19 offset:11584
  s_waitcnt lgkmcnt(6)
  v_mfma_f32_16x16x32_bf16 v[112:115], v[28:31], v[176:179], v[112:115]
  v_mfma_f32_16x16x32_bf16 v[116:119], v[28:31], v[180:183], v[116:119]
  ds_read_b64_tr_b16 v[24:25], v19 offset:9312
  ds_read_b64_tr_b16 v[26:27], v19 offset:11616
  s_waitcnt vmcnt(6)
  s_waitcnt lgkmcnt(6)
  v_mfma_f32_16x16x32_bf16 v[48:51], v[32:35], v[184:187], v[48:51]
  v_mfma_f32_16x16x32_bf16 v[52:55], v[32:35], v[188:191], v[52:55]
  ds_read_b64_tr_b16 v[28:29], v19 offset:9344
  ds_read_b64_tr_b16 v[30:31], v19 offset:11648
  s_waitcnt lgkmcnt(6)
  v_mfma_f32_16x16x32_bf16 v[56:59], v[36:39], v[184:187], v[56:59]
  v_mfma_f32_16x16x32_bf16 v[60:63], v[36:39], v[188:191], v[60:63]
  ds_read_b64_tr_b16 v[32:33], v19 offset:9376
  ds_read_b64_tr_b16 v[34:35], v19 offset:11680
  s_add_u32 s50, s91, 12
  s_and_b32 s50, s50, 15
  s_lshl_b32 s50, s50, 12
  buffer_load_dwordx4 v[216:219], v20, s[28:31], s50 offen offset:0 sc1
  s_waitcnt lgkmcnt(6)
  v_mfma_f32_16x16x32_bf16 v[64:67], v[40:43], v[184:187], v[64:67]
  v_mfma_f32_16x16x32_bf16 v[68:71], v[40:43], v[188:191], v[68:71]
  ds_read_b64_tr_b16 v[36:37], v19 offset:9408
  ds_read_b64_tr_b16 v[38:39], v19 offset:11712
  s_waitcnt lgkmcnt(6)
  v_mfma_f32_16x16x32_bf16 v[72:75], v[24:27], v[184:187], v[72:75]
  v_mfma_f32_16x16x32_bf16 v[76:79], v[24:27], v[188:191], v[76:79]
  ds_read_b64_tr_b16 v[40:41], v19 offset:9440
  ds_read_b64_tr_b16 v[42:43], v19 offset:11744
  buffer_load_dwordx4 v[220:223], v20, s[28:31], s50 offen offset:1024 sc1
  s_waitcnt lgkmcnt(6)
  v_mfma_f32_16x16x32_bf16 v[80:83], v[28:31], v[184:187], v[80:83]
  v_mfma_f32_16x16x32_bf16 v[84:87], v[28:31], v[188:191], v[84:87]
  ds_read_b64_tr_b16 v[24:25], v19 offset:9472
  ds_read_b64_tr_b16 v[26:27], v19 offset:11776
  s_waitcnt lgkmcnt(6)
  v_mfma_f32_16x16x32_bf16 v[88:91], v[32:35], v[184:187], v[88:91]
  v_mfma_f32_16x16x32_bf16 v[92:95], v[32:35], v[188:191], v[92:95]
  ds_read_b64_tr_b16 v[28:29], v19 offset:41984
  ds_read_b64_tr_b16 v[30:31], v19 offset:44288
  s_add_u32 s50, s91, 13
  s_and_b32 s50, s50, 15
  s_lshl_b32 s50, s50, 12
  buffer_load_dwordx4 v[224:227], v20, s[28:31], s50 offen offset:0 sc1
  s_waitcnt lgkmcnt(6)
  v_mfma_f32_16x16x32_bf16 v[96:99], v[36:39], v[184:187], v[96:99]
  v_mfma_f32_16x16x32_bf16 v[100:103], v[36:39], v[188:191], v[100:103]
  ds_read_b64_tr_b16 v[32:33], v19 offset:42016
  ds_read_b64_tr_b16 v[34:35], v19 offset:44320
  s_waitcnt lgkmcnt(6)
  v_mfma_f32_16x16x32_bf16 v[104:107], v[40:43], v[184:187], v[104:107]
  v_mfma_f32_16x16x32_bf16 v[108:111], v[40:43], v[188:191], v[108:111]
  ds_read_b64_tr_b16 v[36:37], v19 offset:42048
  ds_read_b64_tr_b16 v[38:39], v19 offset:44352
  buffer_load_dwordx4 v[228:231], v20, s[28:31], s50 offen offset:1024 sc1
  s_waitcnt lgkmcnt(6)
  v_mfma_f32_16x16x32_bf16 v[112:115], v[24:27], v[184:187], v[112:115]
  v_mfma_f32_16x16x32_bf16 v[116:119], v[24:27], v[188:191], v[116:119]
  ds_read_b64_tr_b16 v[40:41], v19 offset:42080
  ds_read_b64_tr_b16 v[42:43], v19 offset:44384
  s_waitcnt vmcnt(8)
  s_waitcnt lgkmcnt(6)
  v_mfma_f32_16x16x32_bf16 v[48:51], v[28:31], v[192:195], v[48:51]
  v_mfma_f32_16x16x32_bf16 v[52:55], v[28:31], v[196:199], v[52:55]
  ds_read_b64_tr_b16 v[24:25], v19 offset:42112
  ds_read_b64_tr_b16 v[26:27], v19 offset:44416
  s_add_u32 s50, s91, 14
  s_and_b32 s50, s50, 15
  s_lshl_b32 s50, s50, 12
  buffer_load_dwordx4 v[232:235], v20, s[28:31], s50 offen offset:0 sc1
  s_waitcnt lgkmcnt(6)
  v_mfma_f32_16x16x32_bf16 v[56:59], v[32:35], v[192:195], v[56:59]
  v_mfma_f32_16x16x32_bf16 v[60:63], v[32:35], v[196:199], v[60:63]
  ds_read_b64_tr_b16 v[28:29], v19 offset:42144
  ds_read_b64_tr_b16 v[30:31], v19 offset:44448
  s_waitcnt lgkmcnt(6)
  v_mfma_f32_16x16x32_bf16 v[64:67], v[36:39], v[192:195], v[64:67]
  v_mfma_f32_16x16x32_bf16 v[68:71], v[36:39], v[196:199], v[68:71]
  ds_read_b64_tr_b16 v[32:33], v19 offset:42176
  ds_read_b64_tr_b16 v[34:35], v19 offset:44480
  buffer_load_dwordx4 v[236:239], v20, s[28:31], s50 offen offset:1024 sc1
  s_waitcnt lgkmcnt(6)
  v_mfma_f32_16x16x32_bf16 v[72:75], v[40:43], v[192:195], v[72:75]
  v_mfma_f32_16x16x32_bf16 v[76:79], v[40:43], v[196:199], v[76:79]
  ds_read_b64_tr_b16 v[36:37], v19 offset:42208
  ds_read_b64_tr_b16 v[38:39], v19 offset:44512
  s_waitcnt lgkmcnt(6)
  v_mfma_f32_16x16x32_bf16 v[80:83], v[24:27], v[192:195], v[80:83]
  v_mfma_f32_16x16x32_bf16 v[84:87], v[24:27], v[196:199], v[84:87]
  ds_read_b64_tr_b16 v[40:41], v19 offset:42240
  ds_read_b64_tr_b16 v[42:43], v19 offset:44544
  s_add_u32 s50, s91, 15
  s_and_b32 s50, s50, 15
  s_lshl_b32 s50, s50, 12
  buffer_load_dwordx4 v[240:243], v20, s[28:31], s50 offen offset:0 sc1
  s_waitcnt lgkmcnt(6)
  v_mfma_f32_16x16x32_bf16 v[88:91], v[28:31], v[192:195], v[88:91]
  v_mfma_f32_16x16x32_bf16 v[92:95], v[28:31], v[196:199], v[92:95]
  ds_read_b64_tr_b16 v[24:25], v21 offset:9216
  ds_read_b64_tr_b16 v[26:27], v21 offset:11520
  s_waitcnt lgkmcnt(6)
  v_mfma_f32_16x16x32_bf16 v[96:99], v[32:35], v[192:195], v[96:99]
  v_mfma_f32_16x16x32_bf16 v[100:103], v[32:35], v[196:199], v[100:103]
  ds_read_b64_tr_b16 v[28:29], v21 offset:9248
  ds_read_b64_tr_b16 v[30:31], v21 offset:11552
  buffer_load_dwordx4 v[244:247], v20, s[28:31], s50 offen offset:1024 sc1
  s_waitcnt lgkmcnt(6)
  v_mfma_f32_16x16x32_bf16 v[104:107], v[36:39], v[192:195], v[104:107]
  v_mfma_f32_16x16x32_bf16 v[108:111], v[36:39], v[196:199], v[108:111]
  ds_read_b64_tr_b16 v[32:33], v21 offset:9280
  ds_read_b64_tr_b16 v[34:35], v21 offset:11584
  s_waitcnt lgkmcnt(6)
  v_mfma_f32_16x16x32_bf16 v[112:115], v[40:43], v[192:195], v[112:115]
  v_mfma_f32_16x16x32_bf16 v[116:119], v[40:43], v[196:199], v[116:119]
  ds_read_b64_tr_b16 v[36:37], v21 offset:9312
  ds_read_b64_tr_b16 v[38:39], v21 offset:11616
  s_waitcnt vmcnt(10)
  s_waitcnt lgkmcnt(6)
  v_mfma_f32_16x16x32_bf16 v[48:51], v[24:27], v[200:203], v[48:51]
  v_mfma_f32_16x16x32_bf16 v[52:55], v[24:27], v[204:207], v[52:55]
  ds_read_b64_tr_b16 v[40:41], v21 offset:9344
  ds_read_b64_tr_b16 v[42:43], v21 offset:11648
  s_waitcnt lgkmcnt(6)
  v_mfma_f32_16x16x32_bf16 v[56:59], v[28:31], v[200:203], v[56:59]
  v_mfma_f32_16x16x32_bf16 v[60:63], v[28:31], v[204:207], v[60:63]
  ds_read_b64_tr_b16 v[24:25], v21 offset:9376
  ds_read_b64_tr_b16 v[26:27], v21 offset:11680
  s_waitcnt lgkmcnt(6)
  v_mfma_f32_16x16x32_bf16 v[64:67], v[32:35], v[200:203], v[64:67]
  v_mfma_f32_16x16x32_bf16 v[68:71], v[32:35], v[204:207], v[68:71]
  ds_read_b64_tr_b16 v[28:29], v21 offset:9408
  ds_read_b64_tr_b16 v[30:31], v21 offset:11712
  s_waitcnt lgkmcnt(6)
  v_mfma_f32_16x16x32_bf16 v[72:75], v[36:39], v[200:203], v[72:75]
  v_mfma_f32_16x16x32_bf16 v[76:79], v[36:39], v[204:207], v[76:79]
  ds_read_b64_tr_b16 v[32:33], v21 offset:9440
  ds_read_b64_tr_b16 v[34:35], v21 offset:11744
  s_waitcnt lgkmcnt(6)
  v_mfma_f32_16x16x32_bf16 v[80:83], v[40:43], v[200:203], v[80:83]
  v_mfma_f32_16x16x32_bf16 v[84:87], v[40:43], v[204:207], v[84:87]
  ds_read_b64_tr_b16 v[36:37], v21 offset:9472
  ds_read_b64_tr_b16 v[38:39], v21 offset:11776
  s_waitcnt lgkmcnt(6)
  v_mfma_f32_16x16x32_bf16 v[88:91], v[24:27], v[200:203], v[88:91]
  v_mfma_f32_16x16x32_bf16 v[92:95], v[24:27], v[204:207], v[92:95]
  ds_read_b64_tr_b16 v[40:41], v21 offset:41984
  ds_read_b64_tr_b16 v[42:43], v21 offset:44288
  s_waitcnt lgkmcnt(6)
  v_mfma_f32_16x16x32_bf16 v[96:99], v[28:31], v[200:203], v[96:99]
  v_mfma_f32_16x16x32_bf16 v[100:103], v[28:31], v[204:207], v[100:103]
  ds_read_b64_tr_b16 v[24:25], v21 offset:42016
  ds_read_b64_tr_b16 v[26:27], v21 offset:44320
  s_waitcnt lgkmcnt(6)
  v_mfma_f32_16x16x32_bf16 v[104:107], v[32:35], v[200:203], v[104:107]
  v_mfma_f32_16x16x32_bf16 v[108:111], v[32:35], v[204:207], v[108:111]
  ds_read_b64_tr_b16 v[28:29], v21 offset:42048
  ds_read_b64_tr_b16 v[30:31], v21 offset:44352
  s_waitcnt lgkmcnt(6)
  v_mfma_f32_16x16x32_bf16 v[112:115], v[36:39], v[200:203], v[112:115]
  v_mfma_f32_16x16x32_bf16 v[116:119], v[36:39], v[204:207], v[116:119]
  ds_read_b64_tr_b16 v[32:33], v21 offset:42080
  ds_read_b64_tr_b16 v[34:35], v21 offset:44384
  s_waitcnt vmcnt(8)
  s_waitcnt lgkmcnt(6)
  v_mfma_f32_16x16x32_bf16 v[48:51], v[40:43], v[208:211], v[48:51]
  v_mfma_f32_16x16x32_bf16 v[52:55], v[40:43], v[212:215], v[52:55]
  ds_read_b64_tr_b16 v[36:37], v21 offset:42112
  ds_read_b64_tr_b16 v[38:39], v21 offset:44416
  s_waitcnt lgkmcnt(6)
  v_mfma_f32_16x16x32_bf16 v[56:59], v[24:27], v[208:211], v[56:59]
  v_mfma_f32_16x16x32_bf16 v[60:63], v[24:27], v[212:215], v[60:63]
  ds_read_b64_tr_b16 v[40:41], v21 offset:42144
  ds_read_b64_tr_b16 v[42:43], v21 offset:44448
  s_waitcnt lgkmcnt(6)
  v_mfma_f32_16x16x32_bf16 v[64:67], v[28:31], v[208:211], v[64:67]
  v_mfma_f32_16x16x32_bf16 v[68:71], v[28:31], v[212:215], v[68:71]
  ds_read_b64_tr_b16 v[24:25], v21 offset:42176
  ds_read_b64_tr_b16 v[26:27], v21 offset:44480
  s_waitcnt lgkmcnt(6)
  v_mfma_f32_16x16x32_bf16 v[72:75], v[32:35], v[208:211], v[72:75]
  v_mfma_f32_16x16x32_bf16 v[76:79], v[32:35], v[212:215], v[76:79]
  ds_read_b64_tr_b16 v[28:29], v21 offset:42208
  ds_read_b64_tr_b16 v[30:31], v21 offset:44512
  s_waitcnt lgkmcnt(6)
  v_mfma_f32_16x16x32_bf16 v[80:83], v[36:39], v[208:211], v[80:83]
  v_mfma_f32_16x16x32_bf16 v[84:87], v[36:39], v[212:215], v[84:87]
  ds_read_b64_tr_b16 v[32:33], v21 offset:42240
  ds_read_b64_tr_b16 v[34:35], v21 offset:44544
  s_barrier
  s_waitcnt lgkmcnt(6)
  v_mfma_f32_16x16x32_bf16 v[88:91], v[40:43], v[208:211], v[88:91]
  v_mfma_f32_16x16x32_bf16 v[92:95], v[40:43], v[212:215], v[92:95]
  ds_read_b64_tr_b16 v[36:37], v19 offset:23552
  ds_read_b64_tr_b16 v[38:39], v19 offset:25856
  s_waitcnt lgkmcnt(6)
  v_mfma_f32_16x16x32_bf16 v[96:99], v[24:27], v[208:211], v[96:99]
  v_mfma_f32_16x16x32_bf16 v[100:103], v[24:27], v[212:215], v[100:103]
  ds_read_b64_tr_b16 v[40:41], v19 offset:23584
  ds_read_b64_tr_b16 v[42:43], v19 offset:25888
  s_waitcnt lgkmcnt(6)
  v_mfma_f32_16x16x32_bf16 v[104:107], v[28:31], v[208:211], v[104:107]
  v_mfma_f32_16x16x32_bf16 v[108:111], v[28:31], v[212:215], v[108:111]
  ds_read_b64_tr_b16 v[24:25], v19 offset:23616
  ds_read_b64_tr_b16 v[26:27], v19 offset:25920
  s_waitcnt lgkmcnt(6)
  v_mfma_f32_16x16x32_bf16 v[112:115], v[32:35], v[208:211], v[112:115]
  v_mfma_f32_16x16x32_bf16 v[116:119], v[32:35], v[212:215], v[116:119]
  ds_read_b64_tr_b16 v[28:29], v19 offset:23648
  ds_read_b64_tr_b16 v[30:31], v19 offset:25952
  s_waitcnt vmcnt(6)
  s_waitcnt lgkmcnt(6)
  v_mfma_f32_16x16x32_bf16 v[48:51], v[36:39], v[216:219], v[48:51]
  v_mfma_f32_16x16x32_bf16 v[52:55], v[36:39], v[220:223], v[52:55]
  ds_read_b64_tr_b16 v[32:33], v19 offset:23680
  ds_read_b64_tr_b16 v[34:35], v19 offset:25984
  s_waitcnt lgkmcnt(6)
  v_mfma_f32_16x16x32_bf16 v[56:59], v[40:43], v[216:219], v[56:59]
  v_mfma_f32_16x16x32_bf16 v[60:63], v[40:43], v[220:223], v[60:63]
  ds_read_b64_tr_b16 v[36:37], v19 offset:23712
  ds_read_b64_tr_b16 v[38:39], v19 offset:26016
  s_waitcnt lgkmcnt(6)
  v_mfma_f32_16x16x32_bf16 v[64:67], v[24:27], v[216:219], v[64:67]
  v_mfma_f32_16x16x32_bf16 v[68:71], v[24:27], v[220:223], v[68:71]
  ds_read_b64_tr_b16 v[40:41], v19 offset:23744
  ds_read_b64_tr_b16 v[42:43], v19 offset:26048
  s_waitcnt lgkmcnt(6)
  v_mfma_f32_16x16x32_bf16 v[72:75], v[28:31], v[216:219], v[72:75]
  v_mfma_f32_16x16x32_bf16 v[76:79], v[28:31], v[220:223], v[76:79]
  ds_read_b64_tr_b16 v[24:25], v19 offset:23776
  ds_read_b64_tr_b16 v[26:27], v19 offset:26080
  s_waitcnt lgkmcnt(6)
  v_mfma_f32_16x16x32_bf16 v[80:83], v[32:35], v[216:219], v[80:83]
  v_mfma_f32_16x16x32_bf16 v[84:87], v[32:35], v[220:223], v[84:87]
  ds_read_b64_tr_b16 v[28:29], v19 offset:23808
  ds_read_b64_tr_b16 v[30:31], v19 offset:26112
  s_waitcnt lgkmcnt(6)
  v_mfma_f32_16x16x32_bf16 v[88:91], v[36:39], v[216:219], v[88:91]
  v_mfma_f32_16x16x32_bf16 v[92:95], v[36:39], v[220:223], v[92:95]
  ds_read_b64_tr_b16 v[32:33], v19 offset:56320
  ds_read_b64_tr_b16 v[34:35], v19 offset:58624
  s_waitcnt lgkmcnt(6)
  v_mfma_f32_16x16x32_bf16 v[96:99], v[40:43], v[216:219], v[96:99]
  v_mfma_f32_16x16x32_bf16 v[100:103], v[40:43], v[220:223], v[100:103]
  ds_read_b64_tr_b16 v[36:37], v19 offset:56352
  ds_read_b64_tr_b16 v[38:39], v19 offset:58656
  s_waitcnt lgkmcnt(6)
  v_mfma_f32_16x16x32_bf16 v[104:107], v[24:27], v[216:219], v[104:107]
  v_mfma_f32_16x16x32_bf16 v[108:111], v[24:27], v[220:223], v[108:111]
  ds_read_b64_tr_b16 v[40:41], v19 offset:56384
  ds_read_b64_tr_b16 v[42:43], v19 offset:58688
  s_waitcnt lgkmcnt(6)
  v_mfma_f32_16x16x32_bf16 v[112:115], v[28:31], v[216:219], v[112:115]
  v_mfma_f32_16x16x32_bf16 v[116:119], v[28:31], v[220:223], v[116:119]
  ds_read_b64_tr_b16 v[24:25], v19 offset:56416
  ds_read_b64_tr_b16 v[26:27], v19 offset:58720
  s_waitcnt vmcnt(4)
  s_waitcnt lgkmcnt(6)
  v_mfma_f32_16x16x32_bf16 v[48:51], v[32:35], v[224:227], v[48:51]
  v_mfma_f32_16x16x32_bf16 v[52:55], v[32:35], v[228:231], v[52:55]
  ds_read_b64_tr_b16 v[28:29], v19 offset:56448
  ds_read_b64_tr_b16 v[30:31], v19 offset:58752
  s_waitcnt lgkmcnt(6)
  v_mfma_f32_16x16x32_bf16 v[56:59], v[36:39], v[224:227], v[56:59]
  v_mfma_f32_16x16x32_bf16 v[60:63], v[36:39], v[228:231], v[60:63]
  ds_read_b64_tr_b16 v[32:33], v19 offset:56480
  ds_read_b64_tr_b16 v[34:35], v19 offset:58784
  s_waitcnt lgkmcnt(6)
  v_mfma_f32_16x16x32_bf16 v[64:67], v[40:43], v[224:227], v[64:67]
  v_mfma_f32_16x16x32_bf16 v[68:71], v[40:43], v[228:231], v[68:71]
  ds_read_b64_tr_b16 v[36:37], v19 offset:56512
  ds_read_b64_tr_b16 v[38:39], v19 offset:58816
  s_waitcnt lgkmcnt(6)
  v_mfma_f32_16x16x32_bf16 v[72:75], v[24:27], v[224:227], v[72:75]
  v_mfma_f32_16x16x32_bf16 v[76:79], v[24:27], v[228:231], v[76:79]
  ds_read_b64_tr_b16 v[40:41], v19 offset:56544
  ds_read_b64_tr_b16 v[42:43], v19 offset:58848
  s_waitcnt lgkmcnt(6)
  v_mfma_f32_16x16x32_bf16 v[80:83], v[28:31], v[224:227], v[80:83]
  v_mfma_f32_16x16x32_bf16 v[84:87], v[28:31], v[228:231], v[84:87]
  ds_read_b64_tr_b16 v[24:25], v19 offset:56576
  ds_read_b64_tr_b16 v[26:27], v19 offset:58880
  s_waitcnt lgkmcnt(6)
  v_mfma_f32_16x16x32_bf16 v[88:91], v[32:35], v[224:227], v[88:91]
  v_mfma_f32_16x16x32_bf16 v[92:95], v[32:35], v[228:231], v[92:95]
  ds_read_b64_tr_b16 v[28:29], v21 offset:23552
  ds_read_b64_tr_b16 v[30:31], v21 offset:25856
  s_waitcnt lgkmcnt(6)
  v_mfma_f32_16x16x32_bf16 v[96:99], v[36:39], v[224:227], v[96:99]
  v_mfma_f32_16x16x32_bf16 v[100:103], v[36:39], v[228:231], v[100:103]
  ds_read_b64_tr_b16 v[32:33], v21 offset:23584
  ds_read_b64_tr_b16 v[34:35], v21 offset:25888
  s_waitcnt lgkmcnt(6)
  v_mfma_f32_16x16x32_bf16 v[104:107], v[40:43], v[224:227], v[104:107]
  v_mfma_f32_16x16x32_bf16 v[108:111], v[40:43], v[228:231], v[108:111]
  ds_read_b64_tr_b16 v[36:37], v21 offset:23616
  ds_read_b64_tr_b16 v[38:39], v21 offset:25920
  s_waitcnt lgkmcnt(6)
  v_mfma_f32_16x16x32_bf16 v[112:115], v[24:27], v[224:227], v[112:115]
  v_mfma_f32_16x16x32_bf16 v[116:119], v[24:27], v[228:231], v[116:119]
  ds_read_b64_tr_b16 v[40:41], v21 offset:23648
  ds_read_b64_tr_b16 v[42:43], v21 offset:25952
  s_waitcnt vmcnt(2)
  s_waitcnt lgkmcnt(6)
  v_mfma_f32_16x16x32_bf16 v[48:51], v[28:31], v[232:235], v[48:51]
  v_mfma_f32_16x16x32_bf16 v[52:55], v[28:31], v[236:239], v[52:55]
  ds_read_b64_tr_b16 v[24:25], v21 offset:23680
  ds_read_b64_tr_b16 v[26:27], v21 offset:25984
  s_waitcnt lgkmcnt(6)
  v_mfma_f32_16x16x32_bf16 v[56:59], v[32:35], v[232:235], v[56:59]
  v_mfma_f32_16x16x32_bf16 v[60:63], v[32:35], v[236:239], v[60:63]
  ds_read_b64_tr_b16 v[28:29], v21 offset:23712
  ds_read_b64_tr_b16 v[30:31], v21 offset:26016
  s_waitcnt lgkmcnt(6)
  v_mfma_f32_16x16x32_bf16 v[64:67], v[36:39], v[232:235], v[64:67]
  v_mfma_f32_16x16x32_bf16 v[68:71], v[36:39], v[236:239], v[68:71]
  ds_read_b64_tr_b16 v[32:33], v21 offset:23744
  ds_read_b64_tr_b16 v[34:35], v21 offset:26048
  s_waitcnt lgkmcnt(6)
  v_mfma_f32_16x16x32_bf16 v[72:75], v[40:43], v[232:235], v[72:75]
  v_mfma_f32_16x16x32_bf16 v[76:79], v[40:43], v[236:239], v[76:79]
  ds_read_b64_tr_b16 v[36:37], v21 offset:23776
  ds_read_b64_tr_b16 v[38:39], v21 offset:26080
  s_waitcnt lgkmcnt(6)
  v_mfma_f32_16x16x32_bf16 v[80:83], v[24:27], v[232:235], v[80:83]
  v_mfma_f32_16x16x32_bf16 v[84:87], v[24:27], v[236:239], v[84:87]
  ds_read_b64_tr_b16 v[40:41], v21 offset:23808
  ds_read_b64_tr_b16 v[42:43], v21 offset:26112
  s_waitcnt lgkmcnt(6)
  v_mfma_f32_16x16x32_bf16 v[88:91], v[28:31], v[232:235], v[88:91]
  v_mfma_f32_16x16x32_bf16 v[92:95], v[28:31], v[236:239], v[92:95]
  ds_read_b64_tr_b16 v[24:25], v21 offset:56320
  ds_read_b64_tr_b16 v[26:27], v21 offset:58624
  s_waitcnt lgkmcnt(6)
  v_mfma_f32_16x16x32_bf16 v[96:99], v[32:35], v[232:235], v[96:99]
  v_mfma_f32_16x16x32_bf16 v[100:103], v[32:35], v[236:239], v[100:103]
  ds_read_b64_tr_b16 v[28:29], v21 offset:56352
  ds_read_b64_tr_b16 v[30:31], v21 offset:58656
  s_waitcnt lgkmcnt(6)
  v_mfma_f32_16x16x32_bf16 v[104:107], v[36:39], v[232:235], v[104:107]
  v_mfma_f32_16x16x32_bf16 v[108:111], v[36:39], v[236:239], v[108:111]
  ds_read_b64_tr_b16 v[32:33], v21 offset:56384
  ds_read_b64_tr_b16 v[34:35], v21 offset:58688
  s_waitcnt lgkmcnt(6)
  v_mfma_f32_16x16x32_bf16 v[112:115], v[40:43], v[232:235], v[112:115]
  v_mfma_f32_16x16x32_bf16 v[116:119], v[40:43], v[236:239], v[116:119]
  ds_read_b64_tr_b16 v[36:37], v21 offset:56416
  ds_read_b64_tr_b16 v[38:39], v21 offset:58720
  s_waitcnt vmcnt(0)
  s_waitcnt lgkmcnt(6)
  v_mfma_f32_16x16x32_bf16 v[48:51], v[24:27], v[240:243], v[48:51]
  v_mfma_f32_16x16x32_bf16 v[52:55], v[24:27], v[244:247], v[52:55]
  ds_read_b64_tr_b16 v[40:41], v21 offset:56448
  ds_read_b64_tr_b16 v[42:43], v21 offset:58752
  s_waitcnt lgkmcnt(6)
  v_mfma_f32_16x16x32_bf16 v[56:59], v[28:31], v[240:243], v[56:59]
  v_mfma_f32_16x16x32_bf16 v[60:63], v[28:31], v[244:247], v[60:63]
  ds_read_b64_tr_b16 v[24:25], v21 offset:56480
  ds_read_b64_tr_b16 v[26:27], v21 offset:58784
  s_waitcnt lgkmcnt(6)
  v_mfma_f32_16x16x32_bf16 v[64:67], v[32:35], v[240:243], v[64:67]
  v_mfma_f32_16x16x32_bf16 v[68:71], v[32:35], v[244:247], v[68:71]
  ds_read_b64_tr_b16 v[28:29], v21 offset:56512
  ds_read_b64_tr_b16 v[30:31], v21 offset:58816
  s_waitcnt lgkmcnt(6)
  v_mfma_f32_16x16x32_bf16 v[72:75], v[36:39], v[240:243], v[72:75]
  v_mfma_f32_16x16x32_bf16 v[76:79], v[36:39], v[244:247], v[76:79]
  ds_read_b64_tr_b16 v[32:33], v21 offset:56544
  ds_read_b64_tr_b16 v[34:35], v21 offset:58848
  s_waitcnt lgkmcnt(6)
  v_mfma_f32_16x16x32_bf16 v[80:83], v[40:43], v[240:243], v[80:83]
  v_mfma_f32_16x16x32_bf16 v[84:87], v[40:43], v[244:247], v[84:87]
  ds_read_b64_tr_b16 v[36:37], v21 offset:56576
  ds_read_b64_tr_b16 v[38:39], v21 offset:58880
  s_waitcnt lgkmcnt(6)
  v_mfma_f32_16x16x32_bf16 v[88:91], v[24:27], v[240:243], v[88:91]
  v_mfma_f32_16x16x32_bf16 v[92:95], v[24:27], v[244:247], v[92:95]
  s_waitcnt lgkmcnt(4)
  v_mfma_f32_16x16x32_bf16 v[96:99], v[28:31], v[240:243], v[96:99]
  v_mfma_f32_16x16x32_bf16 v[100:103], v[28:31], v[244:247], v[100:103]
  s_waitcnt lgkmcnt(2)
  v_mfma_f32_16x16x32_bf16 v[104:107], v[32:35], v[240:243], v[104:107]
  v_mfma_f32_16x16x32_bf16 v[108:111], v[32:35], v[244:247], v[108:111]
  s_waitcnt lgkmcnt(0)
  v_mfma_f32_16x16x32_bf16 v[112:115], v[36:39], v[240:243], v[112:115]
  v_mfma_f32_16x16x32_bf16 v[116:119], v[36:39], v[244:247], v[116:119]
  s_nop 7
  v_cvt_pk_bf16_f32 v120, v48, v49
  v_cvt_pk_bf16_f32 v121, v50, v51
  v_cvt_pk_bf16_f32 v122, v52, v53
  v_cvt_pk_bf16_f32 v123, v54, v55
  s_mov_b32 s50, 0
  buffer_store_dwordx4 v[120:123], v20, s[32:35], s50 offen sc1
  v_cvt_pk_bf16_f32 v124, v56, v57
  v_cvt_pk_bf16_f32 v125, v58, v59
  v_cvt_pk_bf16_f32 v126, v60, v61
  v_cvt_pk_bf16_f32 v127, v62, v63
  s_mov_b32 s50, 1024
  buffer_store_dwordx4 v[124:127], v20, s[32:35], s50 offen sc1
  v_cvt_pk_bf16_f32 v128, v64, v65
  v_cvt_pk_bf16_f32 v129, v66, v67
  v_cvt_pk_bf16_f32 v130, v68, v69
  v_cvt_pk_bf16_f32 v131, v70, v71
  s_mov_b32 s50, 2048
  buffer_store_dwordx4 v[128:131], v20, s[32:35], s50 offen sc1
  v_cvt_pk_bf16_f32 v132, v72, v73
  v_cvt_pk_bf16_f32 v133, v74, v75
  v_cvt_pk_bf16_f32 v134, v76, v77
  v_cvt_pk_bf16_f32 v135, v78, v79
  s_mov_b32 s50, 3072
  buffer_store_dwordx4 v[132:135], v20, s[32:35], s50 offen sc1
  v_cvt_pk_bf16_f32 v136, v80, v81
  v_cvt_pk_bf16_f32 v137, v82, v83
  v_cvt_pk_bf16_f32 v138, v84, v85
  v_cvt_pk_bf16_f32 v139, v86, v87
  s_mov_b32 s50, 4096
  buffer_store_dwordx4 v[136:139], v20, s[32:35], s50 offen sc1
  v_cvt_pk_bf16_f32 v140, v88, v89
  v_cvt_pk_bf16_f32 v141, v90, v91
  v_cvt_pk_bf16_f32 v142, v92, v93
  v_cvt_pk_bf16_f32 v143, v94, v95
  s_mov_b32 s50, 5120
  buffer_store_dwordx4 v[140:143], v20, s[32:35], s50 offen sc1
  v_cvt_pk_bf16_f32 v144, v96, v97
  v_cvt_pk_bf16_f32 v145, v98, v99
  v_cvt_pk_bf16_f32 v146, v100, v101
  v_cvt_pk_bf16_f32 v147, v102, v103
  s_mov_b32 s50, 6144
  buffer_store_dwordx4 v[144:147], v20, s[32:35], s50 offen sc1
  v_cvt_pk_bf16_f32 v148, v104, v105
  v_cvt_pk_bf16_f32 v149, v106, v107
  v_cvt_pk_bf16_f32 v150, v108, v109
  v_cvt_pk_bf16_f32 v151, v110, v111
  s_mov_b32 s50, 7168
  buffer_store_dwordx4 v[148:151], v20, s[32:35], s50 offen sc1
  v_cvt_pk_bf16_f32 v152, v112, v113
  v_cvt_pk_bf16_f32 v153, v114, v115
  v_cvt_pk_bf16_f32 v154, v116, v117
  v_cvt_pk_bf16_f32 v155, v118, v119
  s_mov_b32 s50, 8192
  buffer_store_dwordx4 v[152:155], v20, s[32:35], s50 offen sc1
  s_lshl_b32 s50, s57, 2
  s_add_u32 s50, s50, s89
  s_lshl_b32 s50, s50, 2
  s_add_u32 s50, s50, s90
  s_mul_i32 s50, s50, 36864
  s_add_u32 s50, s50, 16777216
  s_add_u32 s28, s20, s50
  s_addc_u32 s29, s21, 0
  s_and_b32 s29, s29, 0xffff
  s_mov_b32 s30, 8294400
  s_mov_b32 s31, 0x20000
  s_mov_b32 s24, s8
  s_and_b32 s25, s9, 0xffff
  s_mov_b32 s26, 1179648
  s_mov_b32 s27, 0x20000
  s_mul_i32 s42, s89, 294912
  s_mul_i32 s51, s57, 1152
  s_add_u32 s42, s42, s51
  s_mul_i32 s51, s90, 288
  s_add_u32 s42, s42, s51
  s_mul_i32 s50, s88, 576
  s_lshl_b32 s51, s44, 6
  s_add_u32 s50, s50, s51
  s_add_u32 s50, s50, 0
  v_add_u32 v2, s50, v1
  v_lshlrev_b32 v24, 3, v2
  v_lshrrev_b32 v3, 7, v2
  v_mul_u32_u24 v4, 7282, v3
  v_lshrrev_b32 v4, 16, v4
  v_mul_u32_u24 v5, 9, v4
  v_sub_u32 v3, v3, v5
  v_lshlrev_b32 v3, 5, v3
  v_lshlrev_b32 v4, 5, v4
  v_and_b32 v5, 1, v2
  v_lshlrev_b32 v5, 4, v5
  v_add_u32 v4, v4, v5
  v_bfe_u32 v5, v2, 1, 4
  v_add_u32 v4, v4, v5
  v_mul_u32_u24 v4, 2304, v4
  v_add_u32 v3, v3, v4
  v_bfe_u32 v5, v2, 5, 2
  v_lshlrev_b32 v5, 3, v5
  v_add_u32 v28, v3, v5
  s_mul_i32 s50, s88, 576
  s_lshl_b32 s51, s44, 6
  s_add_u32 s50, s50, s51
  s_add_u32 s50, s50, 256
  v_add_u32 v2, s50, v1
  v_lshlrev_b32 v25, 3, v2
  v_lshrrev_b32 v3, 7, v2
  v_mul_u32_u24 v4, 7282, v3
  v_lshrrev_b32 v4, 16, v4
  v_mul_u32_u24 v5, 9, v4
  v_sub_u32 v3, v3, v5
  v_lshlrev_b32 v3, 5, v3
  v_lshlrev_b32 v4, 5, v4
  v_and_b32 v5, 1, v2
  v_lshlrev_b32 v5, 4, v5
  v_add_u32 v4, v4, v5
  v_bfe_u32 v5, v2, 1, 4
  v_add_u32 v4, v4, v5
  v_mul_u32_u24 v4, 2304, v4
  v_add_u32 v3, v3, v4
  v_bfe_u32 v5, v2, 5, 2
  v_lshlrev_b32 v5, 3, v5
  v_add_u32 v29, v3, v5
  s_mul_i32 s50, s88, 576
  s_lshl_b32 s51, s44, 6
  s_add_u32 s50, s50, s51
  s_mul_i32 s50, s88, 576
  s_add_u32 s50, s50, 512
  v_add_u32 v2, s50, v1
  v_lshlrev_b32 v26, 3, v2
  v_lshrrev_b32 v3, 7, v2
  v_mul_u32_u24 v4, 7282, v3
  v_lshrrev_b32 v4, 16, v4
  v_mul_u32_u24 v5, 9, v4
  v_sub_u32 v3, v3, v5
  v_lshlrev_b32 v3, 5, v3
  v_lshlrev_b32 v4, 5, v4
  v_and_b32 v5, 1, v2
  v_lshlrev_b32 v5, 4, v5
  v_add_u32 v4, v4, v5
  v_bfe_u32 v5, v2, 1, 4
  v_add_u32 v4, v4, v5
  v_mul_u32_u24 v4, 2304, v4
  v_add_u32 v3, v3, v4
  v_bfe_u32 v5, v2, 5, 2
  v_lshlrev_b32 v5, 3, v5
  v_add_u32 v30, v3, v5
  s_waitcnt vmcnt(0)
  s_barrier
  s_lshl_b32 s50, s57, 2
  s_add_u32 s50, s50, s89
  s_lshl_b32 s50, s50, 2
  s_add_u32 s50, s50, s90
  s_lshl_b32 s50, s50, 7
  s_add_u32 s50, s50, 50397184
  s_mov_b32 s51, s88
  s_mov_b32 s43, s50
  s_cmp_lg_u32 s44, 0
  s_cbranch_scc1 L_h2_nopub
  s_lshl_b32 s51, s51, 2
  s_add_u32 s51, s51, s50
  v_mov_b32 v2, s51
  v_mov_b32 v3, s62
  s_mov_b64 s[40:41], exec
  s_mov_b64 exec, 1
  global_store_dword v2, v3, s[20:21] sc1
  s_mov_b64 exec, s[40:41]
L_h2_nopub:
  v_and_b32 v4, 7, v1
  v_lshlrev_b32 v4, 2, v4
  v_add_u32 v4, s43, v4
  s_mov_b32 s52, 131072
  global_load_dword v5, v4, s[20:21] sc1
L_h2_poll:
  global_load_dword v3, v4, s[20:21] sc1
  s_waitcnt vmcnt(1)
  v_cmp_ne_u32 vcc, s62, v5
  s_cbranch_vccz L_h2_ok
  global_load_dword v5, v4, s[20:21] sc1
  s_waitcnt vmcnt(1)
  v_cmp_ne_u32 vcc, s62, v3
  s_cbranch_vccz L_h2_ok
  s_sub_u32 s52, s52, 1
  s_cmp_lg_u32 s52, 0
  s_cbranch_scc1 L_h2_poll
L_h2_ok:
  s_cmp_eq_u32 s44, 0
  s_cbranch_scc1 L_red3
  s_mov_b32 s50, 0
  buffer_load_dwordx2 v[32:33], v24, s[28:31], s50 offen sc1
  s_mov_b32 s50, 1179648
  buffer_load_dwordx2 v[34:35], v24, s[28:31], s50 offen sc1
  s_mov_b32 s50, 2359296
  buffer_load_dwordx2 v[36:37], v24, s[28:31], s50 offen sc1
  s_mov_b32 s50, 3538944
  buffer_load_dwordx2 v[38:39], v24, s[28:31], s50 offen sc1
  s_mov_b32 s50, 4718592
  buffer_load_dwordx2 v[40:41], v24, s[28:31], s50 offen sc1
  s_mov_b32 s50, 5898240
  buffer_load_dwordx2 v[42:43], v24, s[28:31], s50 offen sc1
  s_mov_b32 s50, 7077888
  buffer_load_dwordx2 v[44:45], v24, s[28:31], s50 offen sc1
  s_mov_b32 s50, 8257536
  buffer_load_dwordx2 v[46:47], v24, s[28:31], s50 offen sc1
  s_mov_b32 s50, 0
  buffer_load_dwordx2 v[48:49], v25, s[28:31], s50 offen sc1
  s_mov_b32 s50, 1179648
  buffer_load_dwordx2 v[50:51], v25, s[28:31], s50 offen sc1
  s_mov_b32 s50, 2359296
  buffer_load_dwordx2 v[52:53], v25, s[28:31], s50 offen sc1
  s_mov_b32 s50, 3538944
  buffer_load_dwordx2 v[54:55], v25, s[28:31], s50 offen sc1
  s_mov_b32 s50, 4718592
  buffer_load_dwordx2 v[56:57], v25, s[28:31], s50 offen sc1
  s_mov_b32 s50, 5898240
  buffer_load_dwordx2 v[58:59], v25, s[28:31], s50 offen sc1
  s_mov_b32 s50, 7077888
  buffer_load_dwordx2 v[60:61], v25, s[28:31], s50 offen sc1
  s_mov_b32 s50, 8257536
  buffer_load_dwordx2 v[62:63], v25, s[28:31], s50 offen sc1
  v_mov_b32 v84, 0
  v_mov_b32 v85, 0
  v_mov_b32 v86, 0
  v_mov_b32 v87, 0
  s_waitcnt vmcnt(15)
  v_lshlrev_b32 v88, 16, v32
  v_and_b32 v89, 0xffff0000, v32
  v_add_f32 v84, v84, v88
  v_add_f32 v85, v85, v89
  v_lshlrev_b32 v88, 16, v33
  v_and_b32 v89, 0xffff0000, v33
  v_add_f32 v86, v86, v88
  v_add_f32 v87, v87, v89
  s_waitcnt vmcnt(14)
  v_lshlrev_b32 v88, 16, v34
  v_and_b32 v89, 0xffff0000, v34
  v_add_f32 v84, v84, v88
  v_add_f32 v85, v85, v89
  v_lshlrev_b32 v88, 16, v35
  v_and_b32 v89, 0xffff0000, v35
  v_add_f32 v86, v86, v88
  v_add_f32 v87, v87, v89
  s_waitcnt vmcnt(13)
  v_lshlrev_b32 v88, 16, v36
  v_and_b32 v89, 0xffff0000, v36
  v_add_f32 v84, v84, v88
  v_add_f32 v85, v85, v89
  v_lshlrev_b32 v88, 16, v37
  v_and_b32 v89, 0xffff0000, v37
  v_add_f32 v86, v86, v88
  v_add_f32 v87, v87, v89
  s_waitcnt vmcnt(12)
  v_lshlrev_b32 v88, 16, v38
  v_and_b32 v89, 0xffff0000, v38
  v_add_f32 v84, v84, v88
  v_add_f32 v85, v85, v89
  v_lshlrev_b32 v88, 16, v39
  v_and_b32 v89, 0xffff0000, v39
  v_add_f32 v86, v86, v88
  v_add_f32 v87, v87, v89
  s_waitcnt vmcnt(11)
  v_lshlrev_b32 v88, 16, v40
  v_and_b32 v89, 0xffff0000, v40
  v_add_f32 v84, v84, v88
  v_add_f32 v85, v85, v89
  v_lshlrev_b32 v88, 16, v41
  v_and_b32 v89, 0xffff0000, v41
  v_add_f32 v86, v86, v88
  v_add_f32 v87, v87, v89
  s_waitcnt vmcnt(10)
  v_lshlrev_b32 v88, 16, v42
  v_and_b32 v89, 0xffff0000, v42
  v_add_f32 v84, v84, v88
  v_add_f32 v85, v85, v89
  v_lshlrev_b32 v88, 16, v43
  v_and_b32 v89, 0xffff0000, v43
  v_add_f32 v86, v86, v88
  v_add_f32 v87, v87, v89
  s_waitcnt vmcnt(9)
  v_lshlrev_b32 v88, 16, v44
  v_and_b32 v89, 0xffff0000, v44
  v_add_f32 v84, v84, v88
  v_add_f32 v85, v85, v89
  v_lshlrev_b32 v88, 16, v45
  v_and_b32 v89, 0xffff0000, v45
  v_add_f32 v86, v86, v88
  v_add_f32 v87, v87, v89
  s_waitcnt vmcnt(8)
  v_lshlrev_b32 v88, 16, v46
  v_and_b32 v89, 0xffff0000, v46
  v_add_f32 v84, v84, v88
  v_add_f32 v85, v85, v89
  v_lshlrev_b32 v88, 16, v47
  v_and_b32 v89, 0xffff0000, v47
  v_add_f32 v86, v86, v88
  v_add_f32 v87, v87, v89
  v_cvt_pk_bf16_f32 v90, v84, v85
  v_cvt_pk_bf16_f32 v91, v86, v87
  v_mov_b32 v84, 0
  v_mov_b32 v85, 0
  v_mov_b32 v86, 0
  v_mov_b32 v87, 0
  s_waitcnt vmcnt(7)
  v_lshlrev_b32 v88, 16, v48
  v_and_b32 v89, 0xffff0000, v48
  v_add_f32 v84, v84, v88
  v_add_f32 v85, v85, v89
  v_lshlrev_b32 v88, 16, v49
  v_and_b32 v89, 0xffff0000, v49
  v_add_f32 v86, v86, v88
  v_add_f32 v87, v87, v89
  s_waitcnt vmcnt(6)
  v_lshlrev_b32 v88, 16, v50
  v_and_b32 v89, 0xffff0000, v50
  v_add_f32 v84, v84, v88
  v_add_f32 v85, v85, v89
  v_lshlrev_b32 v88, 16, v51
  v_and_b32 v89, 0xffff0000, v51
  v_add_f32 v86, v86, v88
  v_add_f32 v87, v87, v89
  s_waitcnt vmcnt(5)
  v_lshlrev_b32 v88, 16, v52
  v_and_b32 v89, 0xffff0000, v52
  v_add_f32 v84, v84, v88
  v_add_f32 v85, v85, v89
  v_lshlrev_b32 v88, 16, v53
  v_and_b32 v89, 0xffff0000, v53
  v_add_f32 v86, v86, v88
  v_add_f32 v87, v87, v89
  s_waitcnt vmcnt(4)
  v_lshlrev_b32 v88, 16, v54
  v_and_b32 v89, 0xffff0000, v54
  v_add_f32 v84, v84, v88
  v_add_f32 v85, v85, v89
  v_lshlrev_b32 v88, 16, v55
  v_and_b32 v89, 0xffff0000, v55
  v_add_f32 v86, v86, v88
  v_add_f32 v87, v87, v89
  s_waitcnt vmcnt(3)
  v_lshlrev_b32 v88, 16, v56
  v_and_b32 v89, 0xffff0000, v56
  v_add_f32 v84, v84, v88
  v_add_f32 v85, v85, v89
  v_lshlrev_b32 v88, 16, v57
  v_and_b32 v89, 0xffff0000, v57
  v_add_f32 v86, v86, v88
  v_add_f32 v87, v87, v89
  s_waitcnt vmcnt(2)
  v_lshlrev_b32 v88, 16, v58
  v_and_b32 v89, 0xffff0000, v58
  v_add_f32 v84, v84, v88
  v_add_f32 v85, v85, v89
  v_lshlrev_b32 v88, 16, v59
  v_and_b32 v89, 0xffff0000, v59
  v_add_f32 v86, v86, v88
  v_add_f32 v87, v87, v89
  s_waitcnt vmcnt(1)
  v_lshlrev_b32 v88, 16, v60
  v_and_b32 v89, 0xffff0000, v60
  v_add_f32 v84, v84, v88
  v_add_f32 v85, v85, v89
  v_lshlrev_b32 v88, 16, v61
  v_and_b32 v89, 0xffff0000, v61
  v_add_f32 v86, v86, v88
  v_add_f32 v87, v87, v89
  s_waitcnt vmcnt(0)
  v_lshlrev_b32 v88, 16, v62
  v_and_b32 v89, 0xffff0000, v62
  v_add_f32 v84, v84, v88
  v_add_f32 v85, v85, v89
  v_lshlrev_b32 v88, 16, v63
  v_and_b32 v89, 0xffff0000, v63
  v_add_f32 v86, v86, v88
  v_add_f32 v87, v87, v89
  v_cvt_pk_bf16_f32 v92, v84, v85
  v_cvt_pk_bf16_f32 v93, v86, v87
  buffer_store_dwordx2 v[90:91], v28, s[24:27], s42 offen
  buffer_store_dwordx2 v[92:93], v29, s[24:27], s42 offen
  s_branch L_red_done
L_red3:
  s_mov_b32 s50, 0
  buffer_load_dwordx2 v[32:33], v24, s[28:31], s50 offen sc1
  s_mov_b32 s50, 1179648
  buffer_load_dwordx2 v[34:35], v24, s[28:31], s50 offen sc1
  s_mov_b32 s50, 2359296
  buffer_load_dwordx2 v[36:37], v24, s[28:31], s50 offen sc1
  s_mov_b32 s50, 3538944
  buffer_load_dwordx2 v[38:39], v24, s[28:31], s50 offen sc1
  s_mov_b32 s50, 4718592
  buffer_load_dwordx2 v[40:41], v24, s[28:31], s50 offen sc1
  s_mov_b32 s50, 5898240
  buffer_load_dwordx2 v[42:43], v24, s[28:31], s50 offen sc1
  s_mov_b32 s50, 7077888
  buffer_load_dwordx2 v[44:45], v24, s[28:31], s50 offen sc1
  s_mov_b32 s50, 8257536
  buffer_load_dwordx2 v[46:47], v24, s[28:31], s50 offen sc1
  s_mov_b32 s50, 0
  buffer_load_dwordx2 v[48:49], v25, s[28:31], s50 offen sc1
  s_mov_b32 s50, 1179648
  buffer_load_dwordx2 v[50:51], v25, s[28:31], s50 offen sc1
  s_mov_b32 s50, 2359296
  buffer_load_dwordx2 v[52:53], v25, s[28:31], s50 offen sc1
  s_mov_b32 s50, 3538944
  buffer_load_dwordx2 v[54:55], v25, s[28:31], s50 offen sc1
  s_mov_b32 s50, 4718592
  buffer_load_dwordx2 v[56:57], v25, s[28:31], s50 offen sc1
  s_mov_b32 s50, 5898240
  buffer_load_dwordx2 v[58:59], v25, s[28:31], s50 offen sc1
  s_mov_b32 s50, 7077888
  buffer_load_dwordx2 v[60:61], v25, s[28:31], s50 offen sc1
  s_mov_b32 s50, 8257536
  buffer_load_dwordx2 v[62:63], v25, s[28:31], s50 offen sc1
  s_mov_b32 s50, 0
  buffer_load_dwordx2 v[64:65], v26, s[28:31], s50 offen sc1
  s_mov_b32 s50, 1179648
  buffer_load_dwordx2 v[66:67], v26, s[28:31], s50 offen sc1
  s_mov_b32 s50, 2359296
  buffer_load_dwordx2 v[68:69], v26, s[28:31], s50 offen sc1
  s_mov_b32 s50, 3538944
  buffer_load_dwordx2 v[70:71], v26, s[28:31], s50 offen sc1
  s_mov_b32 s50, 4718592
  buffer_load_dwordx2 v[72:73], v26, s[28:31], s50 offen sc1
  s_mov_b32 s50, 5898240
  buffer_load_dwordx2 v[74:75], v26, s[28:31], s50 offen sc1
  s_mov_b32 s50, 7077888
  buffer_load_dwordx2 v[76:77], v26, s[28:31], s50 offen sc1
  s_mov_b32 s50, 8257536
  buffer_load_dwordx2 v[78:79], v26, s[28:31], s50 offen sc1
  v_mov_b32 v84, 0
  v_mov_b32 v85, 0
  v_mov_b32 v86, 0
  v_mov_b32 v87, 0
  s_waitcnt vmcnt(23)
  v_lshlrev_b32 v88, 16, v32
  v_and_b32 v89, 0xffff0000, v32
  v_add_f32 v84, v84, v88
  v_add_f32 v85, v85, v89
  v_lshlrev_b32 v88, 16, v33
  v_and_b32 v89, 0xffff0000, v33
  v_add_f32 v86, v86, v88
  v_add_f32 v87, v87, v89
  s_waitcnt vmcnt(22)
  v_lshlrev_b32 v88, 16, v34
  v_and_b32 v89, 0xffff0000, v34
  v_add_f32 v84, v84, v88
  v_add_f32 v85, v85, v89
  v_lshlrev_b32 v88, 16, v35
  v_and_b32 v89, 0xffff0000, v35
  v_add_f32 v86, v86, v88
  v_add_f32 v87, v87, v89
  s_waitcnt vmcnt(21)
  v_lshlrev_b32 v88, 16, v36
  v_and_b32 v89, 0xffff0000, v36
  v_add_f32 v84, v84, v88
  v_add_f32 v85, v85, v89
  v_lshlrev_b32 v88, 16, v37
  v_and_b32 v89, 0xffff0000, v37
  v_add_f32 v86, v86, v88
  v_add_f32 v87, v87, v89
  s_waitcnt vmcnt(20)
  v_lshlrev_b32 v88, 16, v38
  v_and_b32 v89, 0xffff0000, v38
  v_add_f32 v84, v84, v88
  v_add_f32 v85, v85, v89
  v_lshlrev_b32 v88, 16, v39
  v_and_b32 v89, 0xffff0000, v39
  v_add_f32 v86, v86, v88
  v_add_f32 v87, v87, v89
  s_waitcnt vmcnt(19)
  v_lshlrev_b32 v88, 16, v40
  v_and_b32 v89, 0xffff0000, v40
  v_add_f32 v84, v84, v88
  v_add_f32 v85, v85, v89
  v_lshlrev_b32 v88, 16, v41
  v_and_b32 v89, 0xffff0000, v41
  v_add_f32 v86, v86, v88
  v_add_f32 v87, v87, v89
  s_waitcnt vmcnt(18)
  v_lshlrev_b32 v88, 16, v42
  v_and_b32 v89, 0xffff0000, v42
  v_add_f32 v84, v84, v88
  v_add_f32 v85, v85, v89
  v_lshlrev_b32 v88, 16, v43
  v_and_b32 v89, 0xffff0000, v43
  v_add_f32 v86, v86, v88
  v_add_f32 v87, v87, v89
  s_waitcnt vmcnt(17)
  v_lshlrev_b32 v88, 16, v44
  v_and_b32 v89, 0xffff0000, v44
  v_add_f32 v84, v84, v88
  v_add_f32 v85, v85, v89
  v_lshlrev_b32 v88, 16, v45
  v_and_b32 v89, 0xffff0000, v45
  v_add_f32 v86, v86, v88
  v_add_f32 v87, v87, v89
  s_waitcnt vmcnt(16)
  v_lshlrev_b32 v88, 16, v46
  v_and_b32 v89, 0xffff0000, v46
  v_add_f32 v84, v84, v88
  v_add_f32 v85, v85, v89
  v_lshlrev_b32 v88, 16, v47
  v_and_b32 v89, 0xffff0000, v47
  v_add_f32 v86, v86, v88
  v_add_f32 v87, v87, v89
  v_cvt_pk_bf16_f32 v90, v84, v85
  v_cvt_pk_bf16_f32 v91, v86, v87
  v_mov_b32 v84, 0
  v_mov_b32 v85, 0
  v_mov_b32 v86, 0
  v_mov_b32 v87, 0
  s_waitcnt vmcnt(15)
  v_lshlrev_b32 v88, 16, v48
  v_and_b32 v89, 0xffff0000, v48
  v_add_f32 v84, v84, v88
  v_add_f32 v85, v85, v89
  v_lshlrev_b32 v88, 16, v49
  v_and_b32 v89, 0xffff0000, v49
  v_add_f32 v86, v86, v88
  v_add_f32 v87, v87, v89
  s_waitcnt vmcnt(14)
  v_lshlrev_b32 v88, 16, v50
  v_and_b32 v89, 0xffff0000, v50
  v_add_f32 v84, v84, v88
  v_add_f32 v85, v85, v89
  v_lshlrev_b32 v88, 16, v51
  v_and_b32 v89, 0xffff0000, v51
  v_add_f32 v86, v86, v88
  v_add_f32 v87, v87, v89
  s_waitcnt vmcnt(13)
  v_lshlrev_b32 v88, 16, v52
  v_and_b32 v89, 0xffff0000, v52
  v_add_f32 v84, v84, v88
  v_add_f32 v85, v85, v89
  v_lshlrev_b32 v88, 16, v53
  v_and_b32 v89, 0xffff0000, v53
  v_add_f32 v86, v86, v88
  v_add_f32 v87, v87, v89
  s_waitcnt vmcnt(12)
  v_lshlrev_b32 v88, 16, v54
  v_and_b32 v89, 0xffff0000, v54
  v_add_f32 v84, v84, v88
  v_add_f32 v85, v85, v89
  v_lshlrev_b32 v88, 16, v55
  v_and_b32 v89, 0xffff0000, v55
  v_add_f32 v86, v86, v88
  v_add_f32 v87, v87, v89
  s_waitcnt vmcnt(11)
  v_lshlrev_b32 v88, 16, v56
  v_and_b32 v89, 0xffff0000, v56
  v_add_f32 v84, v84, v88
  v_add_f32 v85, v85, v89
  v_lshlrev_b32 v88, 16, v57
  v_and_b32 v89, 0xffff0000, v57
  v_add_f32 v86, v86, v88
  v_add_f32 v87, v87, v89
  s_waitcnt vmcnt(10)
  v_lshlrev_b32 v88, 16, v58
  v_and_b32 v89, 0xffff0000, v58
  v_add_f32 v84, v84, v88
  v_add_f32 v85, v85, v89
  v_lshlrev_b32 v88, 16, v59
  v_and_b32 v89, 0xffff0000, v59
  v_add_f32 v86, v86, v88
  v_add_f32 v87, v87, v89
  s_waitcnt vmcnt(9)
  v_lshlrev_b32 v88, 16, v60
  v_and_b32 v89, 0xffff0000, v60
  v_add_f32 v84, v84, v88
  v_add_f32 v85, v85, v89
  v_lshlrev_b32 v88, 16, v61
  v_and_b32 v89, 0xffff0000, v61
  v_add_f32 v86, v86, v88
  v_add_f32 v87, v87, v89
  s_waitcnt vmcnt(8)
  v_lshlrev_b32 v88, 16, v62
  v_and_b32 v89, 0xffff0000, v62
  v_add_f32 v84, v84, v88
  v_add_f32 v85, v85, v89
  v_lshlrev_b32 v88, 16, v63
  v_and_b32 v89, 0xffff0000, v63
  v_add_f32 v86, v86, v88
  v_add_f32 v87, v87, v89
  v_cvt_pk_bf16_f32 v92, v84, v85
  v_cvt_pk_bf16_f32 v93, v86, v87
  v_mov_b32 v84, 0
  v_mov_b32 v85, 0
  v_mov_b32 v86, 0
  v_mov_b32 v87, 0
  s_waitcnt vmcnt(7)
  v_lshlrev_b32 v88, 16, v64
  v_and_b32 v89, 0xffff0000, v64
  v_add_f32 v84, v84, v88
  v_add_f32 v85, v85, v89
  v_lshlrev_b32 v88, 16, v65
  v_and_b32 v89, 0xffff0000, v65
  v_add_f32 v86, v86, v88
  v_add_f32 v87, v87, v89
  s_waitcnt vmcnt(6)
  v_lshlrev_b32 v88, 16, v66
  v_and_b32 v89, 0xffff0000, v66
  v_add_f32 v84, v84, v88
  v_add_f32 v85, v85, v89
  v_lshlrev_b32 v88, 16, v67
  v_and_b32 v89, 0xffff0000, v67
  v_add_f32 v86, v86, v88
  v_add_f32 v87, v87, v89
  s_waitcnt vmcnt(5)
  v_lshlrev_b32 v88, 16, v68
  v_and_b32 v89, 0xffff0000, v68
  v_add_f32 v84, v84, v88
  v_add_f32 v85, v85, v89
  v_lshlrev_b32 v88, 16, v69
  v_and_b32 v89, 0xffff0000, v69
  v_add_f32 v86, v86, v88
  v_add_f32 v87, v87, v89
  s_waitcnt vmcnt(4)
  v_lshlrev_b32 v88, 16, v70
  v_and_b32 v89, 0xffff0000, v70
  v_add_f32 v84, v84, v88
  v_add_f32 v85, v85, v89
  v_lshlrev_b32 v88, 16, v71
  v_and_b32 v89, 0xffff0000, v71
  v_add_f32 v86, v86, v88
  v_add_f32 v87, v87, v89
  s_waitcnt vmcnt(3)
  v_lshlrev_b32 v88, 16, v72
  v_and_b32 v89, 0xffff0000, v72
  v_add_f32 v84, v84, v88
  v_add_f32 v85, v85, v89
  v_lshlrev_b32 v88, 16, v73
  v_and_b32 v89, 0xffff0000, v73
  v_add_f32 v86, v86, v88
  v_add_f32 v87, v87, v89
  s_waitcnt vmcnt(2)
  v_lshlrev_b32 v88, 16, v74
  v_and_b32 v89, 0xffff0000, v74
  v_add_f32 v84, v84, v88
  v_add_f32 v85, v85, v89
  v_lshlrev_b32 v88, 16, v75
  v_and_b32 v89, 0xffff0000, v75
  v_add_f32 v86, v86, v88
  v_add_f32 v87, v87, v89
  s_waitcnt vmcnt(1)
  v_lshlrev_b32 v88, 16, v76
  v_and_b32 v89, 0xffff0000, v76
  v_add_f32 v84, v84, v88
  v_add_f32 v85, v85, v89
  v_lshlrev_b32 v88, 16, v77
  v_and_b32 v89, 0xffff0000, v77
  v_add_f32 v86, v86, v88
  v_add_f32 v87, v87, v89
  s_waitcnt vmcnt(0)
  v_lshlrev_b32 v88, 16, v78
  v_and_b32 v89, 0xffff0000, v78
  v_add_f32 v84, v84, v88
  v_add_f32 v85, v85, v89
  v_lshlrev_b32 v88, 16, v79
  v_and_b32 v89, 0xffff0000, v79
  v_add_f32 v86, v86, v88
  v_add_f32 v87, v87, v89
  v_cvt_pk_bf16_f32 v94, v84, v85
  v_cvt_pk_bf16_f32 v95, v86, v87
  buffer_store_dwordx2 v[90:91], v28, s[24:27], s42 offen
  buffer_store_dwordx2 v[92:93], v29, s[24:27], s42 offen
  buffer_store_dwordx2 v[94:95], v30, s[24:27], s42 offen
L_red_done:
L_k1_done:
  s_endpgm
.section .rodata,"a"
.p2align 6
.amdhsa_kernel concat_heads__gqa_block_cached__mha_block_cached__near_ridge_kernel
  .amdhsa_next_free_vgpr 512
  .amdhsa_next_free_sgpr 102
  .amdhsa_accum_offset 256
  .amdhsa_group_segment_fixed_size 0
  .amdhsa_kernarg_size 104
  .amdhsa_user_sgpr_count 2
  .amdhsa_user_sgpr_kernarg_segment_ptr 1
  .amdhsa_system_sgpr_workgroup_id_x 1
.end_amdhsa_kernel
```
